```python
import torch

def _softmax(x, axis=-1):
    return torch.softmax(x, dim=axis)
def _gelu(x):
    return torch.nn.functional.gelu(x, approximate="tanh")
def _silu(x):
    return torch.nn.functional.silu(x)
def _sigmoid(x):
    return torch.sigmoid(x)
def _layernorm(x, axis=-1, eps=1e-5):
    m = x.mean(dim=axis, keepdim=True)
    v = x.var(dim=axis, keepdim=True, unbiased=False)
    return (x - m) / torch.sqrt(v + eps)
def _scatter_add(tgt, idx, src, axis=0):
    return tgt.clone().index_add_(axis, idx, src)
def _segment_sum(src, seg, n):
    out = torch.zeros((n,) + src.shape[1:], dtype=src.dtype)
    return out.index_add_(0, seg, src)
def _pad(x, pw):
    flat = tuple(v for pair in reversed(pw) for v in pair)
    return torch.nn.functional.pad(x, flat)

kernel_name = 'gated_mix__linear_attn_block__dense_activation_silu__prompt'

def setup_inputs():

    _w = (lambda a: (lambda t: t.to(torch.bfloat16) if t.is_floating_point() else t)(torch.as_tensor(a)))
    def _A_setup():
        B, S, D = 1, 2048, 512
        return {
            "x": _w((lambda *s: torch.randn(*s, dtype=torch.bfloat16) * 0.1)(B, S, D)),
            "wqkv": _w((lambda *s: torch.randn(*s, dtype=torch.bfloat16) * 0.8)(D, 3 * D)),
            "wo": _w((lambda *s: torch.randn(*s, dtype=torch.bfloat16) * 0.4)(D, D)),
        }
    _A_in = _A_setup()

    def _B_setup():
        B, S, D, F = 1, 2048, 512, 1376
        return {
            "x": _w((lambda *s: torch.randn(*s, dtype=torch.bfloat16) * 0.1)(B, S, D)),
            "w1": _w((lambda *s: torch.randn(*s, dtype=torch.bfloat16) * 3.2)(D, F) * (D ** -0.5)),
            "w2": _w((lambda *s: torch.randn(*s, dtype=torch.bfloat16) * 3.2)(F, D) * (F ** -0.5)),
        }
    _B_in = _B_setup()

    return {
        "A_x": _A_in["x"],
        "A_wqkv": _A_in["wqkv"],
        "A_wo": _A_in["wo"],
        "B_x": _B_in["x"],
        "B_w1": _B_in["w1"],
        "B_w2": _B_in["w2"],
        "gate_w": _w((lambda *s: torch.randn(*s, dtype=torch.bfloat16) * 0.1)(512) * 16.0),
    }

def reference(A_x, A_wqkv, A_wo, B_x, B_w1, B_w2, gate_w):
    def _A_ref(x, wqkv, wo):
        B, S, D = x.shape
        H = 32; Dh = D // H
        qkv = (lambda x, *d: x.permute(*d))((x @ wqkv).reshape(B, S, 3, H, Dh), 2, 0, 3, 1, 4)
        q, k, v = qkv[0], qkv[1], qkv[2]
        phi = lambda t: torch.where(t > 0, t + 1, torch.exp(t)) + 1e-6
        pq, pk = phi(q), phi(k)
        kv = torch.einsum("bhsd,bhse->bhde", pk, v)
        z = torch.einsum("bhsd->bhd", pk)
        num = torch.einsum("bhqd,bhde->bhqe", pq, kv)
        den = torch.einsum("bhqd,bhd->bhq", pq, z)[..., None] + 1e-6
        o = num / den
        return (lambda x, *d: x.permute(*d))(o, 0, 2, 1, 3).reshape(B, S, D) @ wo

    def _B_ref(x, w1, w2):
        h = torch.einsum("bsd,df->bsf", x, w1)
        h = _silu(h)
        out = torch.einsum("bsf,fd->bsd", h, w2)
        return out

    x = A_x
    g = _sigmoid((x * gate_w).sum(-1, keepdims=True))
    a = _A_ref(x, A_wqkv, A_wo)
    b = _B_ref(x, B_w1, B_w2)
    return g * a + (1 - g) * b
```

```asm
; @launch grid=(256,1,1) block=(256,1,1) lds=163840
.amdgcn_target "amdgcn-amd-amdhsa--gfx950"
.text
.globl gated_mix__linear_attn_block__dense_activation_silu__prompt_kernel
.p2align 8
.type gated_mix__linear_attn_block__dense_activation_silu__prompt_kernel,@function
gated_mix__linear_attn_block__dense_activation_silu__prompt_kernel:
    s_cmp_ge_u32 s2, 256
    s_cbranch_scc1 L_end
    s_load_dwordx4 s[84:87], s[0:1], 0
    s_load_dwordx4 s[88:91], s[0:1], 32
    s_load_dwordx8 s[92:99], s[0:1], 48
    s_load_dwordx2 s[100:101], s[0:1], 16
    s_getpc_b64 s[66:67]
L_pc:
    v_lshrrev_b32 v2, 6, v0
    v_and_b32 v1, 63, v0
    s_lshr_b32 s53, s2, 3
    v_readfirstlane_b32 s3, v2
    s_lshl_b32 s54, s53, 11
    v_lshl_add_u32 v3, v0, 3, s54
    v_min_u32 v3, L_code_end-L_pc-8, v3
    global_load_dwordx2 v[254:255], v3, s[66:67]
    s_and_b32 s54, s2, 7
    s_and_b32 s55, s53, 3
    s_lshr_b32 s60, s53, 2
    s_and_b32 s56, s54, 3
    s_lshl2_add_u32 s57, s56, s55
    s_and_b32 s61, s60, 1
    s_lshr_b32 s54, s54, 2
    s_lshr_b32 s55, s53, 3
    s_lshl2_add_u32 s58, s54, s55
    s_mul_i32 s36, s3, 40960
    s_lshl2_add_u32 s37, s57, s3
    s_lshl_b32 s37, s37, 15
    v_lshrrev_b32 v6, 3, v1
    v_and_b32 v7, 7, v1
    v_lshrrev_b32 v8, 4, v1
    v_xor_b32 v9, v7, v8
    v_lshlrev_b32 v11, 10, v6
    v_lshl_add_u32 v2, v9, 4, v11
    v_xor_b32 v3, 64, v2
    v_add_u32 v4, 14336, v2
    v_add_u32 v3, 7168, v3
    v_add_u32 v5, 14336, v3
    v_and_b32 v8, 1, v8
    v_lshlrev_b32 v8, 2, v8
    v_xor_b32 v9, v7, v8
    v_lshlrev_b32 v9, 4, v9
    v_add_u32 v10, v11, v9
    v_lshlrev_b32 v27, 4, v1
    s_mul_i32 s73, s58, 11
    s_add_u32 s73, s73, 1
    s_lshr_b32 s73, s73, 1
    s_min_u32 s73, s73, 38
    s_lshl_b32 s54, s73, 6
    s_lshl_b32 s55, s58, 7
    s_add_u32 s55, s55, 1024
    s_movk_i32 s56, 2752
    s_cmp_eq_u32 s61, 0
    s_cselect_b32 s56, 3072, s56
    s_cselect_b32 s54, s55, s54
    s_lshl_b32 s72, s56, 6
    s_mul_i32 s38, s3, s56
    s_lshl4_add_u32 s38, s38, s54
    v_mad_u32_u24 v6, v6, s56, v9
    s_lshl_b32 s55, s56, 3
    s_sub_u32 s55, s55, 1024
    v_add_u32 v7, s55, v6
    s_add_u32 s39, s38, s72
    s_waitcnt lgkmcnt(0)
    s_mov_b32 s4, s84
    s_and_b32 s5, s85, 0xffff
    s_mov_b32 s6, 2097152
    s_mov_b32 s7, 0x00020000
    s_add_u32 m0, s36, 2048
    s_add_u32 s53, s37, 0
    buffer_load_dwordx4 v2, s[4:7], s53 offen lds
    buffer_load_dwordx4 v3, s[4:7], s53 offen offset:1024 lds
    buffer_load_dwordx4 v4, s[4:7], s53 offen offset:2048 lds
    buffer_load_dwordx4 v5, s[4:7], s53 offen offset:3072 lds
    s_cmp_eq_u32 s61, 0
    s_cselect_b32 s8, s86, s88
    s_cselect_b32 s9, s87, s89
    s_mov_b32 s10, 1409024
    s_cselect_b32 s10, 1572864, s10
    s_and_b32 s9, s9, 0xffff
    s_mov_b32 s11, 0x00020000
    s_add_u32 m0, s36, 6144
    s_nop 0
    buffer_load_dwordx4 v6, s[8:11], s38 offen lds
    buffer_load_dwordx4 v7, s[8:11], s38 offen offset:1024 lds
    s_mov_b32 s12, s92
    s_and_b32 s13, s93, 0xffff
    s_mov_b32 s14, 1024
    s_mov_b32 s15, 0x00020000
    s_mov_b32 m0, s36
    v_add_u32 v34, 4096, v27
    buffer_load_dwordx4 v27, s[12:15], 0 offen lds
    buffer_load_dwordx4 v34, s[12:15], 0 offen offset:1024 lds
    s_add_u32 m0, s36, 8192
    s_add_u32 s53, s37, 128
    buffer_load_dwordx4 v2, s[4:7], s53 offen lds
    buffer_load_dwordx4 v3, s[4:7], s53 offen offset:1024 lds
    buffer_load_dwordx4 v4, s[4:7], s53 offen offset:2048 lds
    buffer_load_dwordx4 v5, s[4:7], s53 offen offset:3072 lds
    s_add_u32 m0, s36, 12288
    s_nop 0
    buffer_load_dwordx4 v6, s[8:11], s39 offen lds
    buffer_load_dwordx4 v7, s[8:11], s39 offen offset:1024 lds
    s_lshl1_add_u32 s54, s58, s61
    s_lshl2_add_u32 s54, s54, s3
    s_lshl_b32 s55, s57, 6
    s_add_u32 s54, s54, s55
    s_lshl_b32 s54, s54, 11
    v_lshlrev_b32 v253, 7, v1
    s_mov_b64 exec, 0xffff
    buffer_load_dword v252, v253, s[4:7], s54 offen
    s_mov_b64 exec, -1
    s_lshr_b32 s76, s72, 6
    s_lshl2_add_u32 s54, s57, s3
    s_lshl_b32 s54, s54, 3
    s_lshl_b32 s55, s3, 4
    s_sub_u32 s54, s54, s55
    s_mul_i32 s54, s54, s76
    s_add_u32 s54, s54, s38
    s_movk_i32 s77, 126
    s_cmp_eq_u32 s61, 0
    s_cselect_b32 s77, 1024, s77
    s_cselect_b32 s78, 1024, 0
    s_cselect_b32 s79, 2, 3
    s_sub_u32 s54, s54, s78
    v_and_b32 v252, 3, v1
    v_min_u32 v252, s79, v252
    v_mul_u32_u24 v252, s77, v252
    v_lshrrev_b32 v253, 2, v1
    v_mad_u32_u24 v253, v253, s76, v252
    s_mov_b32 exec_hi, 0
    buffer_load_dword v252, v253, s[8:11], s54 offen
    s_mov_b32 exec_hi, -1
    s_mov_b32 s28, s96
    s_and_b32 s29, s97, 0xffff
    s_mov_b32 s30, 256
    s_mov_b32 s31, 0x00020000
    s_cmp_eq_u32 s2, 255
    s_cbranch_scc0 L_nonon
    s_cmp_eq_u32 s3, 0
    s_cbranch_scc0 L_nonon
    s_memrealtime s[66:67]
    s_waitcnt lgkmcnt(0)
    s_lshr_b32 s53, s66, 30
    s_lshl2_add_u32 s53, s67, s53
    s_or_b32 s53, s53, 0x80000000
    s_lshl_b32 s54, s66, 2
    v_mov_b32 v240, s54
    v_mov_b32 v241, s53
    v_mov_b32 v242, 0
    s_mov_b64 exec, 1
    buffer_store_dwordx2 v[240:241], v242, s[28:31], 0 offen sc1
    s_mov_b64 exec, -1
L_nonon:
    s_and_b32 s74, s58, 1
    s_cmp_ge_u32 s58, 6
    s_cselect_b32 s74, 1, s74
    s_and_b32 s74, s74, s61
    s_lshl_b32 s54, s74, 17
    v_and_b32 v8, 64, v9
    v_mul_u32_u24 v9, s54, v8
    v_add_u32 v8, v9, v6
    v_add_u32 v9, v9, v7
    v_and_b32 v31, 31, v1
    v_lshrrev_b32 v30, 5, v1
    v_lshrrev_b32 v29, 3, v31
    v_lshlrev_b32 v29, 10, v29
    v_and_b32 v28, 7, v31
    v_lshl_add_u32 v29, v28, 7, v29
    v_bfe_u32 v28, v31, 1, 3
    v_xor_b32 v28, v28, v30
    v_lshl_add_u32 v28, v28, 4, v29
    s_xor_b32 s53, s3, 1
    s_mul_i32 s53, s53, 40960
    v_add_u32 v16, s53, v28
    v_add_u32 v12, s36, v28
    v_xor_b32 v29, 32, v28
    v_add_u32 v17, s53, v29
    v_add_u32 v13, s36, v29
    v_xor_b32 v29, 64, v28
    v_add_u32 v18, s53, v29
    v_add_u32 v14, s36, v29
    v_xor_b32 v29, 96, v28
    v_add_u32 v19, s53, v29
    v_add_u32 v15, s36, v29
    v_bfe_u32 v29, v1, 4, 1
    v_xor_b32 v28, v29, v1
    v_and_b32 v28, 1, v28
    v_lshlrev_b32 v28, 10, v28
    v_lshl_add_u32 v20, v30, 4, v28
    v_add_u32 v20, s36, v20
    v_and_b32 v28, 3, v1
    v_lshlrev_b32 v28, 3, v28
    v_lshl_add_u32 v28, v29, 5, v28
    v_bfe_u32 v29, v1, 3, 1
    v_lshl_add_u32 v28, v29, 6, v28
    v_bfe_u32 v29, v1, 2, 2
    v_lshl_add_u32 v28, v29, 7, v28
    s_and_b32 s75, s3, 1
    s_lshl_b32 s55, s75, 6
    v_lshl_add_u32 v21, v30, 10, v28
    v_xor_b32 v21, s55, v21
    v_add_u32 v22, 40960, v21
    v_add_u32 v23, 81920, v21
    v_add_u32 v24, 122880, v21
    v_lshl_add_u32 v25, v30, 9, v28
    s_cmp_eq_u32 s61, 0
    s_cbranch_scc0 L_pathH
    s_mov_b32 s68, 0x3fb8aa3b
    s_mov_b32 s69, s68
    s_mov_b32 s70, 0x358637bd
    s_mov_b32 s71, s70
    s_mov_b32 s12, s90
    s_and_b32 s13, s91, 0xffff
    s_mov_b32 s14, 1409024
    s_mov_b32 s15, 0x00020000
    s_mov_b32 s16, s100
    s_and_b32 s17, s101, 0xffff
    s_mov_b32 s18, 524288
    s_mov_b32 s19, 0x00020000
    s_waitcnt vmcnt(8)
    s_barrier
    ds_read_b64_tr_b16 v[48:49], v21 offset:6144
    ds_read_b64_tr_b16 v[50:51], v21 offset:6656
    ds_read_b128 a[0:3], v12 offset:2048
    ds_read_b128 a[4:7], v16 offset:2048
    ds_read_b128 v[128:131], v20 offset:0
    ds_read_b64_tr_b16 v[52:53], v22 offset:6144
    ds_read_b64_tr_b16 v[54:55], v22 offset:6656
    ds_read_b128 a[8:11], v13 offset:2048
    ds_read_b128 a[12:15], v17 offset:2048
    ds_read_b128 v[132:135], v20 offset:32
    s_waitcnt lgkmcnt(5)
    ds_read_b64_tr_b16 v[56:57], v23 offset:6144
    ds_read_b64_tr_b16 v[58:59], v23 offset:6656
    v_mfma_f32_32x32x16_bf16 v[64:79], a[0:3], v[48:51], 0
    s_add_u32 m0, s36, 14336
    s_add_u32 s53, s37, 256
    buffer_load_dwordx4 v2, s[4:7], s53 offen lds
    s_mov_b32 s20, s98
    ds_read_b128 a[16:19], v14 offset:2048
    ds_read_b128 a[20:23], v18 offset:2048
    v_mfma_f32_32x32x16_bf16 v[80:95], a[4:7], v[48:51], 0
    buffer_load_dwordx4 v3, s[4:7], s53 offen offset:1024 lds
    s_and_b32 s21, s99, 0xffff
    ds_read_b128 v[136:139], v20 offset:64
    v_mfma_f32_16x16x32_bf16 v[44:47], v[128:131], a[0:3], 0
    s_mov_b32 s22, 9437184
    s_waitcnt lgkmcnt(5)
    ds_read_b64_tr_b16 v[60:61], v24 offset:6144
    ds_read_b64_tr_b16 v[62:63], v24 offset:6656
    v_mfma_f32_32x32x16_bf16 v[64:79], a[8:11], v[52:55], v[64:79]
    buffer_load_dwordx4 v4, s[4:7], s53 offen offset:2048 lds
    s_mov_b32 s23, 0x00020000
    ds_read_b128 a[24:27], v15 offset:2048
    ds_read_b128 a[28:31], v19 offset:2048
    v_mfma_f32_32x32x16_bf16 v[80:95], a[12:15], v[52:55], v[80:95]
    buffer_load_dwordx4 v5, s[4:7], s53 offen offset:3072 lds
    s_mul_i32 s62, s58, 4352
    ds_read_b128 v[140:143], v20 offset:96
    v_mfma_f32_16x16x32_bf16 v[44:47], v[132:135], a[8:11], v[44:47]
    s_add_u32 s62, s62, 7864320
    s_waitcnt lgkmcnt(5)
    s_waitcnt vmcnt(6)
    s_barrier
    ds_read_b64_tr_b16 v[48:49], v21 offset:12288
    ds_read_b64_tr_b16 v[50:51], v21 offset:12800
    v_mfma_f32_32x32x16_bf16 v[64:79], a[16:19], v[56:59], v[64:79]
    s_add_u32 m0, s36, 18432
    s_add_u32 s53, s38, 393216
    buffer_load_dwordx4 v6, s[8:11], s53 offen lds
    s_lshl_b32 s33, s58, 9
    ds_read_b128 a[32:35], v12 offset:8192
    ds_read_b128 a[36:39], v16 offset:8192
    v_mfma_f32_32x32x16_bf16 v[80:95], a[20:23], v[56:59], v[80:95]
    buffer_load_dwordx4 v7, s[8:11], s53 offen offset:1024 lds
    s_add_u32 s33, s33, 7962624
    ds_read_b128 v[128:131], v20 offset:128
    v_mfma_f32_16x16x32_bf16 v[44:47], v[136:139], a[16:19], v[44:47]
    s_mov_b32 s63, 0
    s_waitcnt lgkmcnt(5)
    ds_read_b64_tr_b16 v[52:53], v22 offset:12288
    ds_read_b64_tr_b16 v[54:55], v22 offset:12800
    v_mfma_f32_32x32x16_bf16 v[64:79], a[24:27], v[60:63], v[64:79]
    s_add_u32 m0, s36, 20480
    s_add_u32 s53, s37, 384
    buffer_load_dwordx4 v2, s[4:7], s53 offen lds
    s_mul_i32 s54, s3, 1088
    s_add_u32 s54, s54, s62
    s_cmp_eq_u32 s57, 0
    s_cselect_b32 s54, s54, 1073741824
    v_mov_b32 v240, 0
    v_mov_b32 v241, 0
    v_mov_b32 v242, 0
    v_mov_b32 v243, 0
    buffer_store_dwordx4 v[240:243], v27, s[20:23], s54 offen sc1
    buffer_store_dwordx4 v[240:243], v27, s[20:23], s54 offen offset:64 sc1
    ds_read_b128 a[40:43], v13 offset:8192
    ds_read_b128 a[44:47], v17 offset:8192
    v_mfma_f32_32x32x16_bf16 v[80:95], a[28:31], v[60:63], v[80:95]
    buffer_load_dwordx4 v3, s[4:7], s53 offen offset:1024 lds
    s_and_b32 s76, s2, 7
    ds_read_b128 v[132:135], v20 offset:160
    v_mfma_f32_16x16x32_bf16 v[44:47], v[140:143], a[24:27], v[44:47]
    s_lshr_b32 s77, s2, 3
    s_waitcnt lgkmcnt(5)
    ds_read_b64_tr_b16 v[56:57], v23 offset:12288
    ds_read_b64_tr_b16 v[58:59], v23 offset:12800
    v_mfma_f32_32x32x16_bf16 v[64:79], a[32:35], v[48:51], v[64:79]
    buffer_load_dwordx4 v4, s[4:7], s53 offen offset:2048 lds
    s_lshr_b32 s79, s76, 2
    ds_read_b128 a[48:51], v14 offset:8192
    ds_read_b128 a[52:55], v18 offset:8192
    v_mfma_f32_32x32x16_bf16 v[80:95], a[36:39], v[48:51], v[80:95]
    buffer_load_dwordx4 v5, s[4:7], s53 offen offset:3072 lds
    s_add_u32 s78, s76, s79
    ds_read_b128 v[136:139], v20 offset:192
    v_mfma_f32_16x16x32_bf16 v[44:47], v[128:131], a[32:35], v[44:47]
    s_add_u32 s78, s78, 1
    s_waitcnt lgkmcnt(5)
    ds_read_b64_tr_b16 v[60:61], v24 offset:12288
    ds_read_b64_tr_b16 v[62:63], v24 offset:12800
    v_mfma_f32_32x32x16_bf16 v[64:79], a[40:43], v[52:55], v[64:79]
    s_add_u32 m0, s36, 24576
    s_add_u32 s53, s38, 589824
    buffer_load_dwordx4 v6, s[8:11], s53 offen lds
    s_and_b32 s78, s78, 3
    ds_read_b128 a[56:59], v15 offset:8192
    ds_read_b128 a[60:63], v19 offset:8192
    v_mfma_f32_32x32x16_bf16 v[80:95], a[44:47], v[52:55], v[80:95]
    buffer_load_dwordx4 v7, s[8:11], s53 offen offset:1024 lds
    s_xor_b32 s79, s79, 1
    ds_read_b128 v[140:143], v20 offset:224
    v_mfma_f32_16x16x32_bf16 v[44:47], v[132:135], a[40:43], v[44:47]
    s_xor_b32 s60, s61, 1
    s_waitcnt lgkmcnt(5)
    s_waitcnt vmcnt(8)
    s_barrier
    ds_read_b64_tr_b16 v[48:49], v21 offset:18432
    ds_read_b64_tr_b16 v[50:51], v21 offset:18944
    v_mfma_f32_32x32x16_bf16 v[64:79], a[48:51], v[56:59], v[64:79]
    s_add_u32 m0, s36, 2048
    s_add_u32 s53, s37, 512
    buffer_load_dwordx4 v2, s[4:7], s53 offen lds
    s_lshl1_add_u32 s60, s79, s60
    ds_read_b128 a[64:67], v12 offset:14336
    ds_read_b128 a[68:71], v16 offset:14336
    v_mfma_f32_32x32x16_bf16 v[80:95], a[52:55], v[56:59], v[80:95]
    buffer_load_dwordx4 v3, s[4:7], s53 offen offset:1024 lds
    s_bfe_u32 s79, s77, 0x10003
    ds_read_b128 v[128:131], v20 offset:256
    v_mfma_f32_16x16x32_bf16 v[44:47], v[136:139], a[48:51], v[44:47]
    s_lshl1_add_u32 s60, s60, s79
    s_waitcnt lgkmcnt(5)
    ds_read_b64_tr_b16 v[52:53], v22 offset:18432
    ds_read_b64_tr_b16 v[54:55], v22 offset:18944
    v_mfma_f32_32x32x16_bf16 v[64:79], a[56:59], v[60:63], v[64:79]
    buffer_load_dwordx4 v4, s[4:7], s53 offen offset:2048 lds
    s_lshr_b32 s79, s77, 4
    ds_read_b128 a[72:75], v13 offset:14336
    ds_read_b128 a[76:79], v17 offset:14336
    v_mfma_f32_32x32x16_bf16 v[80:95], a[60:63], v[60:63], v[80:95]
    buffer_load_dwordx4 v5, s[4:7], s53 offen offset:3072 lds
    s_lshl1_add_u32 s78, s78, s79
    ds_read_b128 v[132:135], v20 offset:288
    v_mfma_f32_16x16x32_bf16 v[44:47], v[140:143], a[56:59], v[44:47]
    s_and_b32 s77, s77, 3
    s_waitcnt lgkmcnt(5)
    ds_read_b64_tr_b16 v[56:57], v23 offset:18432
    ds_read_b64_tr_b16 v[58:59], v23 offset:18944
    v_mfma_f32_32x32x16_bf16 v[64:79], a[64:67], v[48:51], v[64:79]
    s_add_u32 m0, s36, 6144
    s_add_u32 s53, s38, 786432
    buffer_load_dwordx4 v6, s[8:11], s53 offen lds
    s_lshl2_add_u32 s59, s78, s77
    ds_read_b128 a[80:83], v14 offset:14336
    ds_read_b128 a[84:87], v18 offset:14336
    v_mfma_f32_32x32x16_bf16 v[80:95], a[68:71], v[48:51], v[80:95]
    buffer_load_dwordx4 v7, s[8:11], s53 offen offset:1024 lds
    s_mov_b32 s24, s94
    ds_read_b128 v[136:139], v20 offset:320
    v_mfma_f32_16x16x32_bf16 v[44:47], v[128:131], a[64:67], v[44:47]
    s_and_b32 s25, s95, 0xffff
    s_waitcnt lgkmcnt(5)
    ds_read_b64_tr_b16 v[60:61], v24 offset:18432
    ds_read_b64_tr_b16 v[62:63], v24 offset:18944
    v_mfma_f32_32x32x16_bf16 v[64:79], a[72:75], v[52:55], v[64:79]
    s_add_u32 m0, s36, 26624
    s_add_u32 s53, s37, 640
    buffer_load_dwordx4 v2, s[4:7], s53 offen lds
    s_mov_b32 s26, 2097152
    ds_read_b128 a[88:91], v15 offset:14336
    ds_read_b128 a[92:95], v19 offset:14336
    v_mfma_f32_32x32x16_bf16 v[80:95], a[76:79], v[52:55], v[80:95]
    buffer_load_dwordx4 v3, s[4:7], s53 offen offset:1024 lds
    s_mov_b32 s27, 0x00020000
    ds_read_b128 v[140:143], v20 offset:352
    v_mfma_f32_16x16x32_bf16 v[44:47], v[132:135], a[72:75], v[44:47]
    v_add_u32 v11, 7168, v10
    s_waitcnt lgkmcnt(5)
    s_waitcnt vmcnt(8)
    s_barrier
    ds_read_b64_tr_b16 v[48:49], v21 offset:24576
    ds_read_b64_tr_b16 v[50:51], v21 offset:25088
    v_mfma_f32_32x32x16_bf16 v[64:79], a[80:83], v[56:59], v[64:79]
    buffer_load_dwordx4 v4, s[4:7], s53 offen offset:2048 lds
    v_xor_b32 v26, 64, v25
    ds_read_b128 a[96:99], v12 offset:20480
    ds_read_b128 a[100:103], v16 offset:20480
    v_mfma_f32_32x32x16_bf16 v[80:95], a[84:87], v[56:59], v[80:95]
    buffer_load_dwordx4 v5, s[4:7], s53 offen offset:3072 lds
    v_add_u32 v25, s36, v25
    ds_read_b128 v[128:131], v20 offset:384
    v_mfma_f32_16x16x32_bf16 v[44:47], v[136:139], a[80:83], v[44:47]
    v_add_u32 v26, s36, v26
    s_waitcnt lgkmcnt(5)
    ds_read_b64_tr_b16 v[52:53], v22 offset:24576
    ds_read_b64_tr_b16 v[54:55], v22 offset:25088
    v_mfma_f32_32x32x16_bf16 v[64:79], a[88:91], v[60:63], v[64:79]
    s_add_u32 m0, s36, 8192
    s_add_u32 s53, s38, 983040
    buffer_load_dwordx4 v6, s[8:11], s53 offen lds
    v_lshrrev_b32 v33, 2, v27
    ds_read_b128 a[104:107], v13 offset:20480
    ds_read_b128 a[108:111], v17 offset:20480
    v_mfma_f32_32x32x16_bf16 v[80:95], a[92:95], v[60:63], v[80:95]
    buffer_load_dwordx4 v7, s[8:11], s53 offen offset:1024 lds
    v_and_b32 v32, 3, v1
    ds_read_b128 v[132:135], v20 offset:416
    v_mfma_f32_16x16x32_bf16 v[44:47], v[140:143], a[88:91], v[44:47]
    v_lshlrev_b32 v32, 3, v32
    v_mov_b32 v30, 0
    buffer_load_dwordx2 v[30:31], v30, s[28:31], 0 offen sc1
    s_waitcnt lgkmcnt(5)
    ds_read_b64_tr_b16 v[56:57], v23 offset:24576
    ds_read_b64_tr_b16 v[58:59], v23 offset:25088
    v_mfma_f32_32x32x16_bf16 v[64:79], a[96:99], v[48:51], v[64:79]
    s_add_u32 m0, s36, 10240
    s_add_u32 s53, s37, 768
    buffer_load_dwordx4 v2, s[4:7], s53 offen lds
    s_lshl2_add_u32 s76, s59, s3
    ds_read_b128 a[112:115], v14 offset:20480
    ds_read_b128 a[116:119], v18 offset:20480
    v_mfma_f32_32x32x16_bf16 v[80:95], a[100:103], v[48:51], v[80:95]
    buffer_load_dwordx4 v3, s[4:7], s53 offen offset:1024 lds
    s_lshl_b32 s32, s76, 14
    ds_read_b128 v[136:139], v20 offset:448
    v_mfma_f32_16x16x32_bf16 v[44:47], v[128:131], a[96:99], v[44:47]
    s_lshl_b32 s76, s76, 7
    s_waitcnt lgkmcnt(5)
    ds_read_b64_tr_b16 v[60:61], v24 offset:24576
    ds_read_b64_tr_b16 v[62:63], v24 offset:25088
    v_mfma_f32_32x32x16_bf16 v[64:79], a[104:107], v[52:55], v[64:79]
    buffer_load_dwordx4 v4, s[4:7], s53 offen offset:2048 lds
    s_add_u32 s76, s76, 7929856
    ds_read_b128 a[120:123], v15 offset:20480
    ds_read_b128 a[124:127], v19 offset:20480
    v_mfma_f32_32x32x16_bf16 v[80:95], a[108:111], v[52:55], v[80:95]
    buffer_load_dwordx4 v5, s[4:7], s53 offen offset:3072 lds
    v_add_u32 v32, s76, v32
    ds_read_b128 v[140:143], v20 offset:480
    v_mfma_f32_16x16x32_bf16 v[44:47], v[132:135], a[104:107], v[44:47]
    s_lshl_b32 s78, s60, 7
    s_waitcnt lgkmcnt(5)
    s_waitcnt vmcnt(11)
    s_barrier
    ds_read_b64_tr_b16 v[48:49], v21 offset:6144
    ds_read_b64_tr_b16 v[50:51], v21 offset:6656
    v_mfma_f32_32x32x16_bf16 v[64:79], a[112:115], v[56:59], v[64:79]
    s_add_u32 m0, s36, 14336
    s_add_u32 s53, s38, 1179648
    buffer_load_dwordx4 v6, s[8:11], s53 offen lds
    s_add_u32 s32, s32, s78
    ds_read_b128 a[128:131], v12 offset:2048
    ds_read_b128 a[132:135], v16 offset:2048
    v_mfma_f32_32x32x16_bf16 v[80:95], a[116:119], v[56:59], v[80:95]
    buffer_load_dwordx4 v7, s[8:11], s53 offen offset:1024 lds
    s_mov_b32 s64, 0xffff0000
    ds_read_b128 v[128:131], v20 offset:512
    v_mfma_f32_16x16x32_bf16 v[44:47], v[136:139], a[112:115], v[44:47]
    s_mov_b32 s65, 0xffff0000
    s_waitcnt lgkmcnt(5)
    ds_read_b64_tr_b16 v[52:53], v22 offset:6144
    ds_read_b64_tr_b16 v[54:55], v22 offset:6656
    v_mfma_f32_32x32x16_bf16 v[64:79], a[120:123], v[60:63], v[64:79]
    s_add_u32 m0, s36, 16384
    s_add_u32 s53, s37, 896
    buffer_load_dwordx4 v2, s[4:7], s53 offen lds
    s_mul_i32 s76, s3, 11
    ds_read_b128 a[136:139], v13 offset:2048
    ds_read_b128 a[140:143], v17 offset:2048
    v_mfma_f32_32x32x16_bf16 v[80:95], a[124:127], v[60:63], v[80:95]
    buffer_load_dwordx4 v3, s[4:7], s53 offen offset:1024 lds
    s_add_u32 s77, s76, 6
    ds_read_b128 v[132:135], v20 offset:544
    v_mfma_f32_16x16x32_bf16 v[44:47], v[140:143], a[120:123], v[44:47]
    s_min_u32 s77, s77, 38
    s_waitcnt lgkmcnt(5)
    ds_read_b64_tr_b16 v[56:57], v23 offset:6144
    ds_read_b64_tr_b16 v[58:59], v23 offset:6656
    v_mfma_f32_32x32x16_bf16 v[64:79], a[128:131], v[48:51], v[64:79]
    buffer_load_dwordx4 v4, s[4:7], s53 offen offset:2048 lds
    s_lshl_b32 s40, s76, 15
    ds_read_b128 a[144:147], v14 offset:2048
    ds_read_b128 a[148:151], v18 offset:2048
    v_mfma_f32_32x32x16_bf16 v[80:95], a[132:135], v[48:51], v[80:95]
    buffer_load_dwordx4 v5, s[4:7], s53 offen offset:3072 lds
    s_add_u32 s40, s40, s78
    ds_read_b128 v[136:139], v20 offset:576
    v_mfma_f32_16x16x32_bf16 v[44:47], v[128:131], a[128:131], v[44:47]
    s_lshl_b32 s41, s77, 15
    s_waitcnt lgkmcnt(5)
    ds_read_b64_tr_b16 v[60:61], v24 offset:6144
    ds_read_b64_tr_b16 v[62:63], v24 offset:6656
    v_mfma_f32_32x32x16_bf16 v[64:79], a[136:139], v[52:55], v[64:79]
    s_add_u32 m0, s36, 30720
    s_add_u32 s53, s38, 1376256
    buffer_load_dwordx4 v6, s[8:11], s53 offen lds
    s_add_u32 s41, s41, s78
    ds_read_b128 a[152:155], v15 offset:2048
    ds_read_b128 a[156:159], v19 offset:2048
    v_mfma_f32_32x32x16_bf16 v[80:95], a[140:143], v[52:55], v[80:95]
    buffer_load_dwordx4 v7, s[8:11], s53 offen offset:1024 lds
    s_lshl_b32 s43, s3, 17
    ds_read_b128 v[140:143], v20 offset:608
    v_mfma_f32_16x16x32_bf16 v[44:47], v[132:135], a[136:139], v[44:47]
    s_add_u32 s43, s43, s78
    s_waitcnt lgkmcnt(5)
    s_waitcnt vmcnt(13)
    s_barrier
    ds_read_b64_tr_b16 v[48:49], v21 offset:8192
    ds_read_b64_tr_b16 v[50:51], v21 offset:8704
    v_mfma_f32_32x32x16_bf16 v[64:79], a[144:147], v[56:59], v[64:79]
    s_add_u32 m0, s36, 20480
    s_add_u32 s53, s38, 1024
    buffer_load_dwordx4 v6, s[8:11], s53 offen lds
    s_mul_i32 s78, s59, 241664
    ds_read_b128 a[160:163], v12 offset:26624
    ds_read_b128 a[164:167], v16 offset:26624
    v_mfma_f32_32x32x16_bf16 v[80:95], a[148:151], v[56:59], v[80:95]
    buffer_load_dwordx4 v7, s[8:11], s53 offen offset:1024 lds
    s_lshl_b32 s44, s76, 12
    ds_read_b128 v[128:131], v20 offset:640
    v_mfma_f32_16x16x32_bf16 v[44:47], v[136:139], a[144:147], v[44:47]
    s_add_u32 s44, s44, s78
    s_waitcnt lgkmcnt(5)
    ds_read_b64_tr_b16 v[52:53], v22 offset:8192
    ds_read_b64_tr_b16 v[54:55], v22 offset:8704
    v_mfma_f32_32x32x16_bf16 v[64:79], a[152:155], v[60:63], v[64:79]
    s_add_u32 m0, s36, 22528
    s_add_u32 s53, s38, 197632
    buffer_load_dwordx4 v6, s[8:11], s53 offen lds
    s_lshl_b32 s45, s77, 12
    ds_read_b128 a[168:171], v13 offset:26624
    ds_read_b128 a[172:175], v17 offset:26624
    v_mfma_f32_32x32x16_bf16 v[80:95], a[156:159], v[60:63], v[80:95]
    buffer_load_dwordx4 v7, s[8:11], s53 offen offset:1024 lds
    s_add_u32 s45, s45, s78
    ds_read_b128 v[132:135], v20 offset:672
    v_mfma_f32_16x16x32_bf16 v[44:47], v[140:143], a[152:155], v[44:47]
    s_lshl_b32 s47, s3, 14
    s_lshl2_add_u32 s54, s59, s3
    s_mul_i32 s54, s54, 15360
    s_lshl_b32 s55, s60, 7
    s_add_u32 s54, s54, s55
    v_lshlrev_b32 v253, 10, v1
    v_add_u32 v253, s54, v253
    v_subrev_u32 v251, 1409024, v253
    s_mov_b64 exec, 0x7fff
    buffer_load_dword v252, v253, s[12:15], 0 offen
    buffer_load_dword v252, v251, s[16:19], 0 offen
    s_mov_b64 exec, -1
    s_waitcnt lgkmcnt(5)
    ds_read_b64_tr_b16 v[56:57], v23 offset:8192
    ds_read_b64_tr_b16 v[58:59], v23 offset:8704
    v_mfma_f32_32x32x16_bf16 v[64:79], a[160:163], v[48:51], v[64:79]
    s_add_u32 m0, s36, 24576
    s_add_u32 s53, s38, 394240
    buffer_load_dwordx4 v6, s[8:11], s53 offen lds
    s_add_u32 s47, s47, s78
    ds_read_b128 a[176:179], v14 offset:26624
    ds_read_b128 a[180:183], v18 offset:26624
    v_mfma_f32_32x32x16_bf16 v[80:95], a[164:167], v[48:51], v[80:95]
    buffer_load_dwordx4 v7, s[8:11], s53 offen offset:1024 lds
    s_add_u32 s47, s47, 176128
    ds_read_b128 v[136:139], v20 offset:704
    v_mfma_f32_16x16x32_bf16 v[44:47], v[128:131], a[160:163], v[44:47]
    s_add_u32 s42, s40, 163840
    s_waitcnt lgkmcnt(5)
    ds_read_b64_tr_b16 v[60:61], v24 offset:8192
    ds_read_b64_tr_b16 v[62:63], v24 offset:8704
    v_mfma_f32_32x32x16_bf16 v[64:79], a[168:171], v[52:55], v[64:79]
    s_add_u32 s46, s44, 20480
    ds_read_b128 a[184:187], v15 offset:26624
    ds_read_b128 a[188:191], v19 offset:26624
    v_mfma_f32_32x32x16_bf16 v[80:95], a[172:175], v[52:55], v[80:95]
    s_cmp_eq_u32 s3, 3
    s_cselect_b32 s42, 1073741824, s42
    s_cselect_b32 s46, 1073741824, s46
    ds_read_b128 v[140:143], v20 offset:736
    v_mfma_f32_16x16x32_bf16 v[44:47], v[132:135], a[168:171], v[44:47]
    s_lshr_b32 s76, s3, 1
    s_waitcnt lgkmcnt(5)
    s_waitcnt vmcnt(14)
    s_barrier
    ds_read_b64_tr_b16 v[48:49], v21 offset:14336
    ds_read_b64_tr_b16 v[50:51], v21 offset:14848
    v_mfma_f32_32x32x16_bf16 v[64:79], a[176:179], v[56:59], v[64:79]
    s_lshl1_add_u32 s76, s57, s76
    ds_read_b128 a[192:195], v12 offset:10240
    ds_read_b128 a[196:199], v16 offset:10240
    v_mfma_f32_32x32x16_bf16 v[80:95], a[180:183], v[56:59], v[80:95]
    s_mul_i32 s48, s76, 241664
    ds_read_b128 v[128:131], v20 offset:768
    v_mfma_f32_16x16x32_bf16 v[44:47], v[136:139], a[176:179], v[44:47]
    s_lshl_b32 s78, s58, 13
    s_add_u32 s78, s78, 176128
    s_waitcnt lgkmcnt(5)
    ds_read_b64_tr_b16 v[52:53], v22 offset:14336
    ds_read_b64_tr_b16 v[54:55], v22 offset:14848
    v_mfma_f32_32x32x16_bf16 v[64:79], a[184:187], v[60:63], v[64:79]
    s_add_u32 s48, s48, s78
    ds_read_b128 a[200:203], v13 offset:10240
    ds_read_b128 a[204:207], v17 offset:10240
    v_mfma_f32_32x32x16_bf16 v[80:95], a[188:191], v[60:63], v[80:95]
    s_lshl_b32 s78, s75, 12
    ds_read_b128 v[132:135], v20 offset:800
    v_mfma_f32_16x16x32_bf16 v[44:47], v[140:143], a[184:187], v[44:47]
    s_add_u32 s48, s48, s78
Q_nc_1:
    v_readfirstlane_b32 s51, v30
    v_readfirstlane_b32 s52, v31
    s_nop 1
    s_cmp_lg_u32 s52, 0
    s_cbranch_scc1 Q_nok_2
    s_add_u32 s63, s63, 1
    s_cmp_lt_u32 s63, 0x40000
    s_cbranch_scc0 L_end
    s_sleep 1
    v_mov_b32 v30, 0
    buffer_load_dwordx2 v[30:31], v30, s[28:31], 0 offen sc1
    s_waitcnt vmcnt(0)
    s_branch Q_nc_1
Q_nok_2:
    s_lshl3_add_u32 s55, s3, s33
    s_add_u32 s55, s55, 8192
    s_cmp_eq_u32 s57, 0
    s_cselect_b32 s55, s55, 1073741824
    s_add_u32 s54, s51, 1
    v_mov_b32 v34, s54
    v_mov_b32 v35, s52
    v_mov_b32 v36, 0
    s_mov_b64 exec, 1
    buffer_store_dwordx2 v[34:35], v36, s[20:23], s55 offen sc1
    s_mov_b64 exec, -1
    s_waitcnt lgkmcnt(5)
    ds_read_b64_tr_b16 v[56:57], v23 offset:14336
    ds_read_b64_tr_b16 v[58:59], v23 offset:14848
    v_mfma_f32_32x32x16_bf16 v[64:79], a[192:195], v[48:51], v[64:79]
    s_add_u32 m0, s36, 2048
    s_add_u32 s53, s38, 590848
    buffer_load_dwordx4 v6, s[8:11], s53 offen lds
    s_lshl_b32 s78, s75, 10
    ds_read_b128 a[208:211], v14 offset:10240
    ds_read_b128 a[212:215], v18 offset:10240
    v_mfma_f32_32x32x16_bf16 v[80:95], a[196:199], v[48:51], v[80:95]
    buffer_load_dwordx4 v7, s[8:11], s53 offen offset:1024 lds
    s_xor_b32 s79, s78, 1024
    ds_read_b128 v[136:139], v20 offset:832
    v_mfma_f32_16x16x32_bf16 v[44:47], v[128:131], a[192:195], v[44:47]
    s_add_u32 s49, s48, s79
    s_add_u32 s48, s48, s78
    s_and_b32 s78, s74, s75
    s_mul_i32 s35, s78, 1073741824
    s_add_u32 s35, s35, 16384
    s_lshr_b32 s78, s58, 1
    s_lshl2_add_u32 s76, s76, s78
    s_lshl_b32 s76, s76, 7
    s_and_b32 s78, s58, 1
    s_lshl1_add_u32 s78, s61, s78
    s_lshl1_add_u32 s78, s78, s75
    s_lshl3_add_u32 s76, s78, s76
    s_add_u32 s50, s76, 7929856
    s_add_u32 s54, s60, s59
    s_add_u32 s55, s54, 0
    s_and_b32 s55, s55, 3
    s_lshl_b32 s73, s55, 12
    s_bitcmp1_b32 s55, 1
    s_cselect_b32 s28, s41, s40
    s_cselect_b32 s4, s45, s44
    s_and_b32 s55, s73, 4096
    s_add_u32 s4, s4, s55
    s_lshl3_add_u32 s28, s55, s28
    s_add_u32 s55, s54, 1
    s_and_b32 s55, s55, 3
    s_lshl_b32 s74, s55, 12
    s_bitcmp1_b32 s55, 1
    s_cselect_b32 s29, s41, s40
    s_cselect_b32 s5, s45, s44
    s_and_b32 s55, s74, 4096
    s_add_u32 s5, s5, s55
    s_lshl3_add_u32 s29, s55, s29
    s_add_u32 s55, s54, 2
    s_and_b32 s55, s55, 3
    s_lshl_b32 s78, s55, 12
    s_bitcmp1_b32 s55, 1
    s_cselect_b32 s30, s41, s40
    s_cselect_b32 s6, s45, s44
    s_and_b32 s55, s78, 4096
    s_add_u32 s6, s6, s55
    s_lshl3_add_u32 s30, s55, s30
    s_add_u32 s55, s54, 3
    s_and_b32 s55, s55, 3
    s_lshl_b32 s61, s55, 12
    s_bitcmp1_b32 s55, 1
    s_cselect_b32 s31, s41, s40
    s_cselect_b32 s7, s45, s44
    s_and_b32 s55, s61, 4096
    s_add_u32 s7, s7, s55
    s_lshl3_add_u32 s31, s55, s31
    v_add_u32 v2, 14336, v10
    v_add_u32 v3, 21504, v10
    s_waitcnt lgkmcnt(5)
    ds_read_b64_tr_b16 v[60:61], v24 offset:14336
    ds_read_b64_tr_b16 v[62:63], v24 offset:14848
    v_mfma_f32_32x32x16_bf16 v[64:79], a[200:203], v[52:55], v[64:79]
    ds_read_b128 a[216:219], v15 offset:10240
    ds_read_b128 a[220:223], v19 offset:10240
    v_mfma_f32_32x32x16_bf16 v[80:95], a[204:207], v[52:55], v[80:95]
    ds_read_b128 v[140:143], v20 offset:864
    v_mfma_f32_16x16x32_bf16 v[44:47], v[132:135], a[200:203], v[44:47]
    s_waitcnt lgkmcnt(5)
    s_waitcnt vmcnt(11)
    s_barrier
    ds_read_b64_tr_b16 v[48:49], v21 offset:30720
    ds_read_b64_tr_b16 v[50:51], v21 offset:31232
    v_mfma_f32_32x32x16_bf16 v[64:79], a[208:211], v[56:59], v[64:79]
    ds_read_b128 a[224:227], v12 offset:16384
    ds_read_b128 a[228:231], v16 offset:16384
    v_mfma_f32_32x32x16_bf16 v[80:95], a[212:215], v[56:59], v[80:95]
    ds_read_b128 v[128:131], v20 offset:896
    v_mfma_f32_16x16x32_bf16 v[44:47], v[136:139], a[208:211], v[44:47]
    s_waitcnt lgkmcnt(5)
    ds_read_b64_tr_b16 v[52:53], v22 offset:30720
    ds_read_b64_tr_b16 v[54:55], v22 offset:31232
    v_mfma_f32_32x32x16_bf16 v[64:79], a[216:219], v[60:63], v[64:79]
    ds_read_b128 a[232:235], v13 offset:16384
    ds_read_b128 a[236:239], v17 offset:16384
    v_mfma_f32_32x32x16_bf16 v[80:95], a[220:223], v[60:63], v[80:95]
    ds_read_b128 v[132:135], v20 offset:928
    v_mfma_f32_16x16x32_bf16 v[44:47], v[140:143], a[216:219], v[44:47]
    s_waitcnt lgkmcnt(5)
    ds_read_b64_tr_b16 v[56:57], v23 offset:30720
    ds_read_b64_tr_b16 v[58:59], v23 offset:31232
    v_mfma_f32_32x32x16_bf16 v[64:79], a[224:227], v[48:51], v[64:79]
    s_add_u32 m0, s36, 4096
    s_add_u32 s53, s38, 787456
    buffer_load_dwordx4 v6, s[8:11], s53 offen lds
    ds_read_b128 a[240:243], v14 offset:16384
    ds_read_b128 a[244:247], v18 offset:16384
    v_mfma_f32_32x32x16_bf16 v[80:95], a[228:231], v[48:51], v[80:95]
    buffer_load_dwordx4 v7, s[8:11], s53 offen offset:1024 lds
    ds_read_b128 v[136:139], v20 offset:960
    v_mfma_f32_16x16x32_bf16 v[44:47], v[128:131], a[224:227], v[44:47]
    s_waitcnt lgkmcnt(5)
    ds_read_b64_tr_b16 v[60:61], v24 offset:30720
    ds_read_b64_tr_b16 v[62:63], v24 offset:31232
    v_mfma_f32_32x32x16_bf16 v[64:79], a[232:235], v[52:55], v[64:79]
    s_add_u32 m0, s36, 36864
    s_nop 0
    buffer_load_dwordx4 v10, s[12:15], s28 offen lds
    ds_read_b128 a[248:251], v15 offset:16384
    ds_read_b128 a[252:255], v19 offset:16384
    v_mfma_f32_32x32x16_bf16 v[80:95], a[236:239], v[52:55], v[80:95]
    buffer_load_dwordx4 v11, s[12:15], s28 offen offset:1024 lds
    ds_read_b128 v[140:143], v20 offset:992
    v_mfma_f32_16x16x32_bf16 v[44:47], v[132:135], a[232:235], v[44:47]
    s_waitcnt lgkmcnt(5)
    s_waitcnt vmcnt(11)
    s_barrier
    ds_read_b64_tr_b16 v[48:49], v21 offset:20480
    ds_read_b64_tr_b16 v[50:51], v21 offset:20992
    v_mfma_f32_32x32x16_bf16 v[64:79], a[240:243], v[56:59], v[64:79]
    buffer_load_dwordx4 v2, s[12:15], s28 offen offset:2048 lds
    v_mfma_f32_32x32x16_bf16 v[80:95], a[244:247], v[56:59], v[80:95]
    buffer_load_dwordx4 v3, s[12:15], s28 offen offset:3072 lds
    v_mfma_f32_16x16x32_bf16 v[44:47], v[136:139], a[240:243], v[44:47]
    s_waitcnt lgkmcnt(2)
    ds_read_b64_tr_b16 v[52:53], v22 offset:20480
    ds_read_b64_tr_b16 v[54:55], v22 offset:20992
    v_mfma_f32_32x32x16_bf16 v[64:79], a[248:251], v[60:63], v[64:79]
    s_add_u32 m0, s36, 32768
    s_nop 0
    buffer_load_dwordx4 v10, s[12:15], s29 offen lds
    v_mfma_f32_32x32x16_bf16 v[80:95], a[252:255], v[60:63], v[80:95]
    buffer_load_dwordx4 v11, s[12:15], s29 offen offset:1024 lds
    v_mfma_f32_16x16x32_bf16 v[44:47], v[140:143], a[248:251], v[44:47]
    s_waitcnt lgkmcnt(2)
    ds_read_b64_tr_b16 v[56:57], v23 offset:20480
    ds_read_b64_tr_b16 v[58:59], v23 offset:20992
    v_mfma_f32_32x32x16_bf16 v[96:111], a[0:3], v[48:51], 0
    buffer_load_dwordx4 v2, s[12:15], s29 offen offset:2048 lds
    v_mfma_f32_32x32x16_bf16 v[112:127], a[4:7], v[48:51], 0
    s_waitcnt lgkmcnt(2)
    ds_read_b64_tr_b16 v[60:61], v24 offset:20480
    ds_read_b64_tr_b16 v[62:63], v24 offset:20992
    v_mfma_f32_32x32x16_bf16 v[96:111], a[8:11], v[52:55], v[96:111]
    buffer_load_dwordx4 v3, s[12:15], s29 offen offset:3072 lds
    v_mfma_f32_32x32x16_bf16 v[112:127], a[12:15], v[52:55], v[112:127]
    s_waitcnt lgkmcnt(2)
    ds_read_b64_tr_b16 v[48:49], v21 offset:22528
    ds_read_b64_tr_b16 v[50:51], v21 offset:23040
    v_mfma_f32_32x32x16_bf16 v[96:111], a[16:19], v[56:59], v[96:111]
    s_add_u32 m0, s36, 6144
    s_add_u32 s53, s38, 984064
    buffer_load_dwordx4 v6, s[8:11], s53 offen lds
    v_cndmask_b32 v248, v44, v45, s[64:65]
    v_cvt_pk_bf16_f32 v248, v248, v248
    v_and_b32 v248, 0xffff0000, v248
    v_mul_f32 v248, 0xbfb8aa3b, v248
    v_mfma_f32_32x32x16_bf16 v[112:127], a[20:23], v[56:59], v[112:127]
    v_exp_f32 v248, v248
    s_nop 0
    v_add_f32 v248, 1.0, v248
    s_waitcnt lgkmcnt(2)
    ds_read_b64_tr_b16 v[52:53], v22 offset:22528
    ds_read_b64_tr_b16 v[54:55], v22 offset:23040
    v_mfma_f32_32x32x16_bf16 v[96:111], a[24:27], v[60:63], v[96:111]
    buffer_load_dwordx4 v7, s[8:11], s53 offen offset:1024 lds
    v_rcp_f32 v248, v248
    s_nop 0
    v_cvt_pk_bf16_f32 v248, v248, v248
    v_mfma_f32_32x32x16_bf16 v[112:127], a[28:31], v[60:63], v[112:127]
    v_and_b32 v28, 0xffff0000, v248
    v_add_u32 v34, s36, v33
    ds_write_b32 v34, v28 offset:1024
    s_waitcnt lgkmcnt(3)
    ds_read_b64_tr_b16 v[56:57], v23 offset:22528
    ds_read_b64_tr_b16 v[58:59], v23 offset:23040
    v_mfma_f32_32x32x16_bf16 v[96:111], a[32:35], v[48:51], v[96:111]
    s_add_u32 m0, s36, 8192
    s_add_u32 s53, s38, 1180672
    buffer_load_dwordx4 v6, s[8:11], s53 offen lds
    v_mul_f32 v240, s68, v64
    v_mul_f32 v241, s68, v65
    v_mul_f32 v242, s68, v66
    v_mul_f32 v243, s68, v67
    v_mfma_f32_32x32x16_bf16 v[112:127], a[36:39], v[48:51], v[112:127]
    v_exp_f32_e64 v240, v240 clamp
    v_exp_f32_e64 v241, v241 clamp
    s_waitcnt lgkmcnt(3)
    ds_read_b64_tr_b16 v[60:61], v24 offset:22528
    ds_read_b64_tr_b16 v[62:63], v24 offset:23040
    v_mfma_f32_32x32x16_bf16 v[96:111], a[40:43], v[52:55], v[96:111]
    buffer_load_dwordx4 v7, s[8:11], s53 offen offset:1024 lds
    v_exp_f32_e64 v242, v242 clamp
    v_exp_f32_e64 v243, v243 clamp
    v_mfma_f32_32x32x16_bf16 v[112:127], a[44:47], v[52:55], v[112:127]
    v_max_f32 v64, 0, v64
    v_max_f32 v65, 0, v65
    v_max_f32 v66, 0, v66
    v_max_f32 v67, 0, v67
    s_waitcnt lgkmcnt(2)
    s_waitcnt vmcnt(14)
    s_barrier
    s_xor_b32 s54, s3, 1
    s_mul_i32 s54, s54, 40960
    v_add_u32 v34, s54, v33
    ds_read_b32 v29, v34 offset:1024
    ds_read_b64_tr_b16 v[48:49], v21 offset:24576
    ds_read_b64_tr_b16 v[50:51], v21 offset:25088
    v_mfma_f32_32x32x16_bf16 v[96:111], a[48:51], v[56:59], v[96:111]
    s_add_u32 m0, s36, 28672
    s_nop 0
    buffer_load_dwordx4 v10, s[12:15], s30 offen lds
    v_add_f32 v240, v240, v64
    v_add_f32 v241, v241, v65
    v_add_f32 v242, v242, v66
    v_add_f32 v243, v243, v67
    v_mfma_f32_32x32x16_bf16 v[112:127], a[52:55], v[56:59], v[112:127]
    v_add_f32 v240, s70, v240
    v_add_f32 v241, s70, v241
    v_add_f32 v242, s70, v242
    v_add_f32 v243, s70, v243
    s_waitcnt lgkmcnt(3)
    ds_read_b64_tr_b16 v[52:53], v22 offset:24576
    ds_read_b64_tr_b16 v[54:55], v22 offset:25088
    v_mfma_f32_32x32x16_bf16 v[96:111], a[56:59], v[60:63], v[96:111]
    buffer_load_dwordx4 v11, s[12:15], s30 offen offset:1024 lds
    v_mul_f32 v244, s68, v68
    v_mul_f32 v245, s68, v69
    v_mul_f32 v246, s68, v70
    v_mul_f32 v247, s68, v71
    v_mfma_f32_32x32x16_bf16 v[112:127], a[60:63], v[60:63], v[112:127]
    v_exp_f32_e64 v244, v244 clamp
    v_exp_f32_e64 v245, v245 clamp
    v_and_b32 v37, 3, v1
    v_lshlrev_b32 v37, 3, v37
    v_add_u32 v37, 8192, v37
    buffer_load_dwordx2 v[30:31], v37, s[20:23], s33 offen sc1
    s_waitcnt lgkmcnt(2)
    ds_read_b64_tr_b16 v[56:57], v23 offset:24576
    ds_read_b64_tr_b16 v[58:59], v23 offset:25088
    v_mfma_f32_32x32x16_bf16 v[96:111], a[64:67], v[48:51], v[96:111]
    buffer_load_dwordx4 v2, s[12:15], s30 offen offset:2048 lds
    v_exp_f32_e64 v246, v246 clamp
    v_exp_f32_e64 v247, v247 clamp
    v_mfma_f32_32x32x16_bf16 v[112:127], a[68:71], v[48:51], v[112:127]
    v_max_f32 v68, 0, v68
    v_max_f32 v69, 0, v69
    v_max_f32 v70, 0, v70
    v_max_f32 v71, 0, v71
    s_waitcnt lgkmcnt(2)
    ds_read_b64_tr_b16 v[60:61], v24 offset:24576
    ds_read_b64_tr_b16 v[62:63], v24 offset:25088
    v_mfma_f32_32x32x16_bf16 v[96:111], a[72:75], v[52:55], v[96:111]
    buffer_load_dwordx4 v3, s[12:15], s30 offen offset:3072 lds
    v_add_f32 v244, v244, v68
    v_add_f32 v245, v245, v69
    v_add_f32 v246, v246, v70
    v_add_f32 v247, v247, v71
    v_mfma_f32_32x32x16_bf16 v[112:127], a[76:79], v[52:55], v[112:127]
    v_add_f32 v244, s70, v244
    v_add_f32 v245, s70, v245
    v_add_f32 v246, s70, v246
    v_add_f32 v247, s70, v247
    s_waitcnt lgkmcnt(2)
    ds_read_b64_tr_b16 v[48:49], v21 offset:2048
    ds_read_b64_tr_b16 v[50:51], v21 offset:2560
    v_mfma_f32_32x32x16_bf16 v[96:111], a[80:83], v[56:59], v[96:111]
    s_add_u32 m0, s36, 10240
    s_add_u32 s53, s38, 1377280
    buffer_load_dwordx4 v6, s[8:11], s53 offen lds
    v_cvt_pk_bf16_f32 v160, v240, v241
    v_cvt_pk_bf16_f32 v161, v242, v243
    v_cvt_pk_bf16_f32 v162, v244, v245
    v_cvt_pk_bf16_f32 v163, v246, v247
    v_mfma_f32_32x32x16_bf16 v[112:127], a[84:87], v[56:59], v[112:127]
    v_mul_f32 v240, s68, v72
    v_mul_f32 v241, s68, v73
    v_mul_f32 v242, s68, v74
    v_mul_f32 v243, s68, v75
    s_waitcnt lgkmcnt(2)
    ds_read_b64_tr_b16 v[52:53], v22 offset:2048
    ds_read_b64_tr_b16 v[54:55], v22 offset:2560
    v_mfma_f32_32x32x16_bf16 v[96:111], a[88:91], v[60:63], v[96:111]
    buffer_load_dwordx4 v7, s[8:11], s53 offen offset:1024 lds
    v_exp_f32_e64 v240, v240 clamp
    v_exp_f32_e64 v241, v241 clamp
    v_mfma_f32_32x32x16_bf16 v[112:127], a[92:95], v[60:63], v[112:127]
    v_exp_f32_e64 v242, v242 clamp
    v_exp_f32_e64 v243, v243 clamp
    s_waitcnt lgkmcnt(2)
    ds_read_b64_tr_b16 v[56:57], v23 offset:2048
    ds_read_b64_tr_b16 v[58:59], v23 offset:2560
    v_mfma_f32_32x32x16_bf16 v[96:111], a[96:99], v[48:51], v[96:111]
    s_add_u32 m0, s36, 12288
    s_add_u32 s53, s38, 4294966272
    buffer_load_dwordx4 v6, s[8:11], s53 offen lds
    v_max_f32 v72, 0, v72
    v_max_f32 v73, 0, v73
    v_max_f32 v74, 0, v74
    v_max_f32 v75, 0, v75
    v_mfma_f32_32x32x16_bf16 v[112:127], a[100:103], v[48:51], v[112:127]
    v_add_f32 v240, v240, v72
    v_add_f32 v241, v241, v73
    v_add_f32 v242, v242, v74
    v_add_f32 v243, v243, v75
    s_waitcnt lgkmcnt(2)
    ds_read_b64_tr_b16 v[60:61], v24 offset:2048
    ds_read_b64_tr_b16 v[62:63], v24 offset:2560
    v_mfma_f32_32x32x16_bf16 v[96:111], a[104:107], v[52:55], v[96:111]
    buffer_load_dwordx4 v7, s[8:11], s53 offen offset:1024 lds
    v_add_f32 v240, s70, v240
    v_add_f32 v241, s70, v241
    v_add_f32 v242, s70, v242
    v_add_f32 v243, s70, v243
    v_mfma_f32_32x32x16_bf16 v[112:127], a[108:111], v[52:55], v[112:127]
    v_mul_f32 v244, s68, v76
    v_mul_f32 v245, s68, v77
    v_mul_f32 v246, s68, v78
    v_mul_f32 v247, s68, v79
    s_waitcnt lgkmcnt(2)
    s_waitcnt vmcnt(11)
    s_barrier
    ds_read_b64_tr_b16 v[48:49], v21 offset:4096
    ds_read_b64_tr_b16 v[50:51], v21 offset:4608
    v_mfma_f32_32x32x16_bf16 v[96:111], a[112:115], v[56:59], v[96:111]
    s_add_u32 m0, s36, 24576
    s_nop 0
    buffer_load_dwordx4 v10, s[12:15], s31 offen lds
    v_exp_f32_e64 v244, v244 clamp
    v_exp_f32_e64 v245, v245 clamp
    v_mfma_f32_32x32x16_bf16 v[112:127], a[116:119], v[56:59], v[112:127]
    v_exp_f32_e64 v246, v246 clamp
    v_exp_f32_e64 v247, v247 clamp
    s_waitcnt lgkmcnt(2)
    ds_read_b64_tr_b16 v[52:53], v22 offset:4096
    ds_read_b64_tr_b16 v[54:55], v22 offset:4608
    v_mfma_f32_32x32x16_bf16 v[96:111], a[120:123], v[60:63], v[96:111]
    buffer_load_dwordx4 v11, s[12:15], s31 offen offset:1024 lds
    v_max_f32 v76, 0, v76
    v_max_f32 v77, 0, v77
    v_max_f32 v78, 0, v78
    v_max_f32 v79, 0, v79
    v_mfma_f32_32x32x16_bf16 v[112:127], a[124:127], v[60:63], v[112:127]
    v_add_f32 v244, v244, v76
    v_add_f32 v245, v245, v77
    v_add_f32 v246, v246, v78
    v_add_f32 v247, v247, v79
    s_waitcnt lgkmcnt(2)
    ds_read_b64_tr_b16 v[56:57], v23 offset:4096
    ds_read_b64_tr_b16 v[58:59], v23 offset:4608
    v_mfma_f32_32x32x16_bf16 v[96:111], a[128:131], v[48:51], v[96:111]
    buffer_load_dwordx4 v2, s[12:15], s31 offen offset:2048 lds
    v_add_f32 v244, s70, v244
    v_add_f32 v245, s70, v245
    v_add_f32 v246, s70, v246
    v_add_f32 v247, s70, v247
    v_mfma_f32_32x32x16_bf16 v[112:127], a[132:135], v[48:51], v[112:127]
    v_cvt_pk_bf16_f32 v164, v240, v241
    v_cvt_pk_bf16_f32 v165, v242, v243
    v_cvt_pk_bf16_f32 v166, v244, v245
    v_cvt_pk_bf16_f32 v167, v246, v247
    s_waitcnt lgkmcnt(2)
    ds_read_b64_tr_b16 v[60:61], v24 offset:4096
    ds_read_b64_tr_b16 v[62:63], v24 offset:4608
    v_mfma_f32_32x32x16_bf16 v[96:111], a[136:139], v[52:55], v[96:111]
    buffer_load_dwordx4 v3, s[12:15], s31 offen offset:3072 lds
    v_mul_f32 v240, s68, v80
    v_mul_f32 v241, s68, v81
    v_mul_f32 v242, s68, v82
    v_mul_f32 v243, s68, v83
    v_mfma_f32_32x32x16_bf16 v[112:127], a[140:143], v[52:55], v[112:127]
    v_exp_f32_e64 v240, v240 clamp
    v_exp_f32_e64 v241, v241 clamp
    s_waitcnt lgkmcnt(2)
    ds_read_b64_tr_b16 v[48:49], v21 offset:6144
    ds_read_b64_tr_b16 v[50:51], v21 offset:6656
    v_mfma_f32_32x32x16_bf16 v[96:111], a[144:147], v[56:59], v[96:111]
    s_add_u32 m0, s36, 14336
    s_add_u32 s53, s38, 195584
    buffer_load_dwordx4 v6, s[8:11], s53 offen lds
    v_exp_f32_e64 v242, v242 clamp
    v_exp_f32_e64 v243, v243 clamp
    v_mfma_f32_32x32x16_bf16 v[112:127], a[148:151], v[56:59], v[112:127]
    v_max_f32 v80, 0, v80
    v_max_f32 v81, 0, v81
    v_max_f32 v82, 0, v82
    v_max_f32 v83, 0, v83
    s_waitcnt lgkmcnt(2)
    ds_read_b64_tr_b16 v[52:53], v22 offset:6144
    ds_read_b64_tr_b16 v[54:55], v22 offset:6656
    v_mfma_f32_32x32x16_bf16 v[96:111], a[152:155], v[60:63], v[96:111]
    buffer_load_dwordx4 v7, s[8:11], s53 offen offset:1024 lds
    v_add_f32 v240, v240, v80
    v_add_f32 v241, v241, v81
    v_add_f32 v242, v242, v82
    v_add_f32 v243, v243, v83
    v_mfma_f32_32x32x16_bf16 v[112:127], a[156:159], v[60:63], v[112:127]
    v_add_f32 v240, s70, v240
    v_add_f32 v241, s70, v241
    v_add_f32 v242, s70, v242
    v_add_f32 v243, s70, v243
    s_waitcnt lgkmcnt(2)
    ds_read_b64_tr_b16 v[56:57], v23 offset:6144
    ds_read_b64_tr_b16 v[58:59], v23 offset:6656
    v_mfma_f32_32x32x16_bf16 v[96:111], a[160:163], v[48:51], v[96:111]
    s_add_u32 m0, s36, 16384
    s_add_u32 s53, s38, 392192
    buffer_load_dwordx4 v6, s[8:11], s53 offen lds
    v_mul_f32 v244, s68, v84
    v_mul_f32 v245, s68, v85
    v_mul_f32 v246, s68, v86
    v_mul_f32 v247, s68, v87
    v_mfma_f32_32x32x16_bf16 v[112:127], a[164:167], v[48:51], v[112:127]
    v_exp_f32_e64 v244, v244 clamp
    v_exp_f32_e64 v245, v245 clamp
    s_waitcnt lgkmcnt(2)
    ds_read_b64_tr_b16 v[60:61], v24 offset:6144
    ds_read_b64_tr_b16 v[62:63], v24 offset:6656
    v_mfma_f32_32x32x16_bf16 v[96:111], a[168:171], v[52:55], v[96:111]
    buffer_load_dwordx4 v7, s[8:11], s53 offen offset:1024 lds
    v_exp_f32_e64 v246, v246 clamp
    v_exp_f32_e64 v247, v247 clamp
    v_mfma_f32_32x32x16_bf16 v[112:127], a[172:175], v[52:55], v[112:127]
    v_max_f32 v84, 0, v84
    v_max_f32 v85, 0, v85
    v_max_f32 v86, 0, v86
    v_max_f32 v87, 0, v87
    s_waitcnt lgkmcnt(2)
    s_waitcnt vmcnt(10)
    s_barrier
    ds_read_b64_tr_b16 v[48:49], v21 offset:8192
    ds_read_b64_tr_b16 v[50:51], v21 offset:8704
    v_mfma_f32_32x32x16_bf16 v[96:111], a[176:179], v[56:59], v[96:111]
    s_add_u32 m0, s36, 20480
    s_add_u32 s53, s28, 65536
    buffer_load_dwordx4 v10, s[12:15], s53 offen lds
    v_add_f32 v244, v244, v84
    v_add_f32 v245, v245, v85
    v_add_f32 v246, v246, v86
    v_add_f32 v247, v247, v87
    v_mfma_f32_32x32x16_bf16 v[112:127], a[180:183], v[56:59], v[112:127]
    v_add_f32 v244, s70, v244
    v_add_f32 v245, s70, v245
    v_add_f32 v246, s70, v246
    v_add_f32 v247, s70, v247
    s_waitcnt lgkmcnt(2)
    ds_read_b64_tr_b16 v[52:53], v22 offset:8192
    ds_read_b64_tr_b16 v[54:55], v22 offset:8704
    v_mfma_f32_32x32x16_bf16 v[96:111], a[184:187], v[60:63], v[96:111]
    buffer_load_dwordx4 v11, s[12:15], s53 offen offset:1024 lds
    v_cvt_pk_bf16_f32 v168, v240, v241
    v_cvt_pk_bf16_f32 v169, v242, v243
    v_cvt_pk_bf16_f32 v170, v244, v245
    v_cvt_pk_bf16_f32 v171, v246, v247
    v_mfma_f32_32x32x16_bf16 v[112:127], a[188:191], v[60:63], v[112:127]
    v_mul_f32 v240, s68, v88
    v_mul_f32 v241, s68, v89
    v_mul_f32 v242, s68, v90
    v_mul_f32 v243, s68, v91
Q_pc_3:
    s_add_u32 s54, s51, 1
    v_subrev_u32 v38, s54, v30
    v_cmp_eq_u32 s[66:67], s52, v31
    v_cmp_ge_u32 vcc, 2, v38
    s_nop 1
    s_and_b64 vcc, vcc, s[66:67]
    s_cmp_eq_u64 vcc, -1
    s_cbranch_scc1 Q_pok_4
    s_add_u32 s63, s63, 1
    s_cmp_lt_u32 s63, 0x40000
    s_cbranch_scc0 L_end
    s_sleep 1
    buffer_load_dwordx2 v[30:31], v37, s[20:23], s33 offen sc1
    s_waitcnt vmcnt(0)
    s_branch Q_pc_3
Q_pok_4:
    s_waitcnt lgkmcnt(2)
    ds_read_b64_tr_b16 v[56:57], v23 offset:8192
    ds_read_b64_tr_b16 v[58:59], v23 offset:8704
    v_mfma_f32_32x32x16_bf16 v[96:111], a[192:195], v[48:51], v[96:111]
    buffer_load_dwordx4 v2, s[12:15], s53 offen offset:2048 lds
    v_exp_f32_e64 v240, v240 clamp
    v_exp_f32_e64 v241, v241 clamp
    v_mfma_f32_32x32x16_bf16 v[112:127], a[196:199], v[48:51], v[112:127]
    v_exp_f32_e64 v242, v242 clamp
    v_exp_f32_e64 v243, v243 clamp
    s_waitcnt lgkmcnt(2)
    ds_read_b64_tr_b16 v[60:61], v24 offset:8192
    ds_read_b64_tr_b16 v[62:63], v24 offset:8704
    v_mfma_f32_32x32x16_bf16 v[96:111], a[200:203], v[52:55], v[96:111]
    buffer_load_dwordx4 v3, s[12:15], s53 offen offset:3072 lds
    v_max_f32 v88, 0, v88
    v_max_f32 v89, 0, v89
    v_max_f32 v90, 0, v90
    v_max_f32 v91, 0, v91
    v_mfma_f32_32x32x16_bf16 v[112:127], a[204:207], v[52:55], v[112:127]
    v_add_f32 v240, v240, v88
    v_add_f32 v241, v241, v89
    v_add_f32 v242, v242, v90
    s_waitcnt lgkmcnt(2)
    ds_read_b64_tr_b16 v[48:49], v21 offset:10240
    ds_read_b64_tr_b16 v[50:51], v21 offset:10752
    v_mfma_f32_32x32x16_bf16 v[96:111], a[208:211], v[56:59], v[96:111]
    s_add_u32 m0, s36, 2048
    s_add_u32 s53, s38, 588800
    buffer_load_dwordx4 v6, s[8:11], s53 offen lds
    v_add_f32 v243, v243, v91
    v_add_f32 v240, s70, v240
    v_add_f32 v241, s70, v241
    v_mfma_f32_32x32x16_bf16 v[112:127], a[212:215], v[56:59], v[112:127]
    v_add_f32 v242, s70, v242
    v_add_f32 v243, s70, v243
    v_mul_f32 v244, s68, v92
    s_waitcnt lgkmcnt(2)
    ds_read_b64_tr_b16 v[52:53], v22 offset:10240
    ds_read_b64_tr_b16 v[54:55], v22 offset:10752
    v_mfma_f32_32x32x16_bf16 v[96:111], a[216:219], v[60:63], v[96:111]
    buffer_load_dwordx4 v7, s[8:11], s53 offen offset:1024 lds
    v_mul_f32 v245, s68, v93
    v_mul_f32 v246, s68, v94
    v_mul_f32 v247, s68, v95
    v_mfma_f32_32x32x16_bf16 v[112:127], a[220:223], v[60:63], v[112:127]
    v_exp_f32_e64 v244, v244 clamp
    s_waitcnt lgkmcnt(2)
    ds_read_b64_tr_b16 v[56:57], v23 offset:10240
    ds_read_b64_tr_b16 v[58:59], v23 offset:10752
    v_mfma_f32_32x32x16_bf16 v[96:111], a[224:227], v[48:51], v[96:111]
    s_add_u32 m0, s36, 4096
    s_add_u32 s53, s38, 785408
    buffer_load_dwordx4 v6, s[8:11], s53 offen lds
    v_exp_f32_e64 v245, v245 clamp
    v_exp_f32_e64 v246, v246 clamp
    v_mfma_f32_32x32x16_bf16 v[112:127], a[228:231], v[48:51], v[112:127]
    v_exp_f32_e64 v247, v247 clamp
    v_max_f32 v92, 0, v92
    s_waitcnt lgkmcnt(2)
    ds_read_b64_tr_b16 v[60:61], v24 offset:10240
    ds_read_b64_tr_b16 v[62:63], v24 offset:10752
    v_mfma_f32_32x32x16_bf16 v[96:111], a[232:235], v[52:55], v[96:111]
    buffer_load_dwordx4 v7, s[8:11], s53 offen offset:1024 lds
    v_max_f32 v93, 0, v93
    v_max_f32 v94, 0, v94
    v_max_f32 v95, 0, v95
    v_add_f32 v244, v244, v92
    v_mfma_f32_32x32x16_bf16 v[112:127], a[236:239], v[52:55], v[112:127]
    v_add_f32 v245, v245, v93
    v_add_f32 v246, v246, v94
    v_add_f32 v247, v247, v95
    s_waitcnt lgkmcnt(2)
    s_waitcnt vmcnt(10)
    s_barrier
    ds_read_b64_tr_b16 v[48:49], v21 offset:12288
    ds_read_b64_tr_b16 v[50:51], v21 offset:12800
    v_mfma_f32_32x32x16_bf16 v[96:111], a[240:243], v[56:59], v[96:111]
    v_add_f32 v244, s70, v244
    v_add_f32 v245, s70, v245
    v_add_f32 v246, s70, v246
    v_add_f32 v247, s70, v247
    v_cvt_pk_bf16_f32 v172, v240, v241
    v_cvt_pk_bf16_f32 v173, v242, v243
    v_cvt_pk_bf16_f32 v174, v244, v245
    v_mfma_f32_32x32x16_bf16 v[112:127], a[244:247], v[56:59], v[112:127]
    v_cvt_pk_bf16_f32 v175, v246, v247
    s_waitcnt lgkmcnt(2)
    ds_read_b64_tr_b16 v[52:53], v22 offset:12288
    ds_read_b64_tr_b16 v[54:55], v22 offset:12800
    v_mfma_f32_32x32x16_bf16 v[96:111], a[248:251], v[60:63], v[96:111]
    v_mfma_f32_32x32x16_bf16 v[112:127], a[252:255], v[60:63], v[112:127]
    s_waitcnt lgkmcnt(2)
    ds_read_b64_tr_b16 v[56:57], v23 offset:12288
    ds_read_b64_tr_b16 v[58:59], v23 offset:12800
    v_mfma_f32_32x32x16_bf16 v[64:79], v[48:51], a[0:3], 0
    v_mfma_f32_32x32x16_bf16 v[80:95], v[48:51], a[4:7], 0
    s_waitcnt lgkmcnt(2)
    ds_read_b64_tr_b16 v[60:61], v24 offset:12288
    ds_read_b64_tr_b16 v[62:63], v24 offset:12800
    v_mfma_f32_32x32x16_bf16 v[64:79], v[52:55], a[8:11], v[64:79]
    v_mfma_f32_32x32x16_bf16 v[80:95], v[52:55], a[12:15], v[80:95]
    s_waitcnt lgkmcnt(2)
    ds_read_b64_tr_b16 v[48:49], v21 offset:14336
    ds_read_b64_tr_b16 v[50:51], v21 offset:14848
    v_mfma_f32_32x32x16_bf16 v[64:79], v[56:59], a[16:19], v[64:79]
    v_cvt_pk_bf16_f32 v176, v96, v97
    v_cvt_pk_bf16_f32 v177, v98, v99
    v_cvt_pk_bf16_f32 v178, v100, v101
    v_cvt_pk_bf16_f32 v179, v102, v103
    v_cvt_pk_bf16_f32 v180, v104, v105
    v_cvt_pk_bf16_f32 v181, v106, v107
    v_cvt_pk_bf16_f32 v182, v108, v109
    v_cvt_pk_bf16_f32 v183, v110, v111
    v_cvt_pk_bf16_f32 v184, v112, v113
    v_cvt_pk_bf16_f32 v185, v114, v115
    v_cvt_pk_bf16_f32 v186, v116, v117
    v_cvt_pk_bf16_f32 v187, v118, v119
    v_cvt_pk_bf16_f32 v188, v120, v121
    v_cvt_pk_bf16_f32 v189, v122, v123
    v_cvt_pk_bf16_f32 v190, v124, v125
    v_cvt_pk_bf16_f32 v191, v126, v127
    v_mov_b32 v240, 0x3f803f80
    v_mov_b32 v241, 0x3f803f80
    v_mov_b32 v242, 0x3f803f80
    v_mov_b32 v243, 0x3f803f80
    s_nop 1
    v_mfma_f32_32x32x16_bf16 v[192:207], v[160:163], v[176:179], 0
    v_mfma_f32_32x32x16_bf16 v[80:95], v[56:59], a[20:23], v[80:95]
    v_mfma_f32_32x32x16_bf16 v[192:207], v[164:167], v[180:183], v[192:207]
    v_mfma_f32_32x32x16_bf16 v[192:207], v[168:171], v[184:187], v[192:207]
    v_mfma_f32_32x32x16_bf16 v[192:207], v[172:175], v[188:191], v[192:207]
    s_waitcnt lgkmcnt(2)
    ds_read_b64_tr_b16 v[52:53], v22 offset:14336
    ds_read_b64_tr_b16 v[54:55], v22 offset:14848
    v_mfma_f32_32x32x16_bf16 v[64:79], v[60:63], a[24:27], v[64:79]
    v_mfma_f32_32x32x16_bf16 v[208:223], v[240:243], v[160:163], 0
    v_mfma_f32_32x32x16_bf16 v[208:223], v[240:243], v[164:167], v[208:223]
    v_mfma_f32_32x32x16_bf16 v[208:223], v[240:243], v[168:171], v[208:223]
    v_mfma_f32_32x32x16_bf16 v[80:95], v[60:63], a[28:31], v[80:95]
    v_mfma_f32_32x32x16_bf16 v[208:223], v[240:243], v[172:175], v[208:223]
    s_nop 7
    v_cndmask_b32 v176, v192, v200, s[64:65]
    v_cndmask_b32 v177, v193, v201, s[64:65]
    v_cndmask_b32 v178, v194, v202, s[64:65]
    v_cndmask_b32 v179, v195, v203, s[64:65]
    v_cndmask_b32 v180, v196, v204, s[64:65]
    v_cndmask_b32 v181, v197, v205, s[64:65]
    v_cndmask_b32 v182, v198, v206, s[64:65]
    v_cndmask_b32 v183, v199, v207, s[64:65]
    s_waitcnt lgkmcnt(2)
    ds_read_b64_tr_b16 v[56:57], v23 offset:14336
    ds_read_b64_tr_b16 v[58:59], v23 offset:14848
    v_mfma_f32_32x32x16_bf16 v[64:79], v[48:51], a[32:35], v[64:79]
    v_add_u32 v241, s36, v27
    ds_write_b128 v241, v[176:179] offset:0
    ds_write_b128 v241, v[180:183] offset:1024
    s_lshl_b32 s56, s75, 7
    s_add_u32 s56, s56, s62
    s_add_u32 s56, s56, 4096
    s_mov_b32 exec_hi, 0
    buffer_atomic_add_f32 v208, v33, s[20:23], s56 offen
    s_mov_b32 exec_hi, -1
    s_mul_i32 s56, s75, 40960
    s_lshr_b32 s55, s3, 1
    s_lshl_b32 s55, s55, 10
    s_add_u32 s56, s56, s55
    v_add_u32 v241, s56, v33
    v_add_u32 v243, 81920, v241
    v_mfma_f32_32x32x16_bf16 v[80:95], v[48:51], a[36:39], v[80:95]
    s_waitcnt lgkmcnt(4)
    ds_read_b64_tr_b16 v[60:61], v24 offset:14336
    ds_read_b64_tr_b16 v[62:63], v24 offset:14848
    v_mfma_f32_32x32x16_bf16 v[64:79], v[52:55], a[40:43], v[64:79]
    v_mfma_f32_32x32x16_bf16 v[80:95], v[52:55], a[44:47], v[80:95]
    s_waitcnt lgkmcnt(4)
    s_waitcnt vmcnt(3) lgkmcnt(2)
    s_barrier
    ds_read2st64_b32 v[192:193], v241 offset0:0 offset1:1
    ds_read2st64_b32 v[194:195], v241 offset0:2 offset1:3
    ds_read2st64_b32 v[196:197], v243 offset0:0 offset1:1
    ds_read2st64_b32 v[198:199], v243 offset0:2 offset1:3
    ds_read_b64_tr_b16 v[48:49], v21 offset:16384
    ds_read_b64_tr_b16 v[50:51], v21 offset:16896
    v_mfma_f32_32x32x16_bf16 v[64:79], v[56:59], a[48:51], v[64:79]
    s_nop 0
    s_waitcnt lgkmcnt(2)
    v_add_f32 v192, v192, v196
    v_add_f32 v193, v193, v197
    v_add_f32 v194, v194, v198
    v_add_f32 v195, v195, v199
    s_lshr_b32 s55, s3, 1
    s_lshl1_add_u32 s56, s75, s55
    s_lshl_b32 s56, s56, 10
    s_add_u32 s56, s56, s62
    buffer_atomic_add_f32 v192, v33, s[20:23], s56 offen
    buffer_atomic_add_f32 v193, v33, s[20:23], s56 offen offset:256
    buffer_atomic_add_f32 v194, v33, s[20:23], s56 offen offset:512
    buffer_atomic_add_f32 v195, v33, s[20:23], s56 offen offset:768
    v_mfma_f32_32x32x16_bf16 v[80:95], v[56:59], a[52:55], v[80:95]
    ds_read_b64_tr_b16 v[52:53], v22 offset:16384
    ds_read_b64_tr_b16 v[54:55], v22 offset:16896
    v_mfma_f32_32x32x16_bf16 v[64:79], v[60:63], a[56:59], v[64:79]
    s_add_u32 m0, s36, 6144
    s_add_u32 s53, s38, 982016
    buffer_load_dwordx4 v6, s[8:11], s53 offen lds
    v_mfma_f32_32x32x16_bf16 v[80:95], v[60:63], a[60:63], v[80:95]
    s_waitcnt lgkmcnt(2)
    ds_read_b64_tr_b16 v[56:57], v23 offset:16384
    ds_read_b64_tr_b16 v[58:59], v23 offset:16896
    v_mfma_f32_32x32x16_bf16 v[64:79], v[48:51], a[64:67], v[64:79]
    buffer_load_dwordx4 v7, s[8:11], s53 offen offset:1024 lds
    ds_read_b64_tr_b16 a[0:1], v25 offset:36864
    ds_read_b64_tr_b16 a[2:3], v25 offset:37888
    ds_read_b64_tr_b16 a[4:5], v26 offset:36864
    ds_read_b64_tr_b16 a[6:7], v26 offset:37888
    v_mfma_f32_32x32x16_bf16 v[80:95], v[48:51], a[68:71], v[80:95]
    s_waitcnt lgkmcnt(6)
    ds_read_b64_tr_b16 v[60:61], v24 offset:16384
    ds_read_b64_tr_b16 v[62:63], v24 offset:16896
    v_mfma_f32_32x32x16_bf16 v[64:79], v[52:55], a[72:75], v[64:79]
    s_add_u32 m0, s36, 8192
    s_add_u32 s53, s38, 1178624
    buffer_load_dwordx4 v6, s[8:11], s53 offen lds
    ds_read_b64_tr_b16 a[8:9], v25 offset:38912
    ds_read_b64_tr_b16 a[10:11], v25 offset:39936
    ds_read_b64_tr_b16 a[12:13], v26 offset:38912
    ds_read_b64_tr_b16 a[14:15], v26 offset:39936
    v_mfma_f32_32x32x16_bf16 v[80:95], v[52:55], a[76:79], v[80:95]
    s_waitcnt lgkmcnt(10)
    ds_read_b64_tr_b16 v[48:49], v21 offset:2048
    ds_read_b64_tr_b16 v[50:51], v21 offset:2560
    v_mfma_f32_32x32x16_bf16 v[64:79], v[56:59], a[80:83], v[64:79]
    buffer_load_dwordx4 v7, s[8:11], s53 offen offset:1024 lds
    ds_read_b64_tr_b16 a[16:17], v25 offset:32768
    ds_read_b64_tr_b16 a[18:19], v25 offset:33792
    ds_read_b64_tr_b16 a[20:21], v26 offset:32768
    ds_read_b64_tr_b16 a[22:23], v26 offset:33792
    v_mfma_f32_32x32x16_bf16 v[80:95], v[56:59], a[84:87], v[80:95]
    s_add_u32 m0, s36, 10240
    s_add_u32 s53, s38, 1375232
    buffer_load_dwordx4 v6, s[8:11], s53 offen lds
    s_waitcnt vmcnt(5)
    s_lshl2_add_u32 s55, s57, s3
    s_lshl3_add_u32 s55, s55, s33
    s_add_u32 s54, s51, 1
    v_mov_b32 v34, s54
    v_mov_b32 v35, s52
    v_mov_b32 v36, 0
    s_mov_b64 exec, 1
    buffer_store_dwordx2 v[34:35], v36, s[20:23], s55 offen sc1
    s_mov_b64 exec, -1
    s_waitcnt lgkmcnt(10)
    ds_read_b64_tr_b16 v[52:53], v22 offset:2048
    ds_read_b64_tr_b16 v[54:55], v22 offset:2560
    v_mfma_f32_32x32x16_bf16 v[64:79], v[60:63], a[88:91], v[64:79]
    buffer_load_dwordx4 v7, s[8:11], s53 offen offset:1024 lds
    ds_read_b64_tr_b16 a[24:25], v25 offset:34816
    ds_read_b64_tr_b16 a[26:27], v25 offset:35840
    ds_read_b64_tr_b16 a[28:29], v26 offset:34816
    ds_read_b64_tr_b16 a[30:31], v26 offset:35840
    v_mfma_f32_32x32x16_bf16 v[80:95], v[60:63], a[92:95], v[80:95]
    s_waitcnt lgkmcnt(10)
    ds_read_b64_tr_b16 v[56:57], v23 offset:2048
    ds_read_b64_tr_b16 v[58:59], v23 offset:2560
    v_mfma_f32_32x32x16_bf16 v[64:79], v[48:51], a[96:99], v[64:79]
    ds_read_b64_tr_b16 a[32:33], v25 offset:28672
    ds_read_b64_tr_b16 a[34:35], v25 offset:29696
    ds_read_b64_tr_b16 a[36:37], v26 offset:28672
    ds_read_b64_tr_b16 a[38:39], v26 offset:29696
    v_mfma_f32_32x32x16_bf16 v[80:95], v[48:51], a[100:103], v[80:95]
    s_waitcnt lgkmcnt(10)
    ds_read_b64_tr_b16 v[60:61], v24 offset:2048
    ds_read_b64_tr_b16 v[62:63], v24 offset:2560
    v_mfma_f32_32x32x16_bf16 v[64:79], v[52:55], a[104:107], v[64:79]
    s_add_u32 m0, s36, 36864
    s_add_u32 s53, s29, 65536
    buffer_load_dwordx4 v10, s[12:15], s53 offen lds
    ds_read_b64_tr_b16 a[40:41], v25 offset:30720
    ds_read_b64_tr_b16 a[42:43], v25 offset:31744
    ds_read_b64_tr_b16 a[44:45], v26 offset:30720
    ds_read_b64_tr_b16 a[46:47], v26 offset:31744
    v_mfma_f32_32x32x16_bf16 v[80:95], v[52:55], a[108:111], v[80:95]
    s_waitcnt lgkmcnt(10)
    s_waitcnt vmcnt(6)
    s_barrier
    ds_read_b64_tr_b16 v[48:49], v21 offset:4096
    ds_read_b64_tr_b16 v[50:51], v21 offset:4608
    v_mfma_f32_32x32x16_bf16 v[64:79], v[56:59], a[112:115], v[64:79]
    buffer_load_dwordx4 v11, s[12:15], s53 offen offset:1024 lds
    ds_read_b64_tr_b16 a[48:49], v25 offset:24576
    ds_read_b64_tr_b16 a[50:51], v25 offset:25600
    ds_read_b64_tr_b16 a[52:53], v26 offset:24576
    ds_read_b64_tr_b16 a[54:55], v26 offset:25600
    v_mfma_f32_32x32x16_bf16 v[80:95], v[56:59], a[116:119], v[80:95]
    buffer_load_dwordx4 v2, s[12:15], s53 offen offset:2048 lds
    s_waitcnt lgkmcnt(10)
    ds_read_b64_tr_b16 v[52:53], v22 offset:4096
    ds_read_b64_tr_b16 v[54:55], v22 offset:4608
    v_mfma_f32_32x32x16_bf16 v[64:79], v[60:63], a[120:123], v[64:79]
    buffer_load_dwordx4 v3, s[12:15], s53 offen offset:3072 lds
    ds_read_b64_tr_b16 a[56:57], v25 offset:26624
    ds_read_b64_tr_b16 a[58:59], v25 offset:27648
    ds_read_b64_tr_b16 a[60:61], v26 offset:26624
    ds_read_b64_tr_b16 a[62:63], v26 offset:27648
    v_mfma_f32_32x32x16_bf16 v[80:95], v[60:63], a[124:127], v[80:95]
    s_waitcnt lgkmcnt(10)
    ds_read_b64_tr_b16 v[56:57], v23 offset:4096
    ds_read_b64_tr_b16 v[58:59], v23 offset:4608
    v_mfma_f32_32x32x16_bf16 v[64:79], v[48:51], a[128:131], v[64:79]
    s_add_u32 m0, s36, 32768
    s_add_u32 s53, s30, 65536
    buffer_load_dwordx4 v10, s[12:15], s53 offen lds
    ds_read_b64_tr_b16 a[64:65], v25 offset:20480
    ds_read_b64_tr_b16 a[66:67], v25 offset:21504
    ds_read_b64_tr_b16 a[68:69], v26 offset:20480
    ds_read_b64_tr_b16 a[70:71], v26 offset:21504
    v_mfma_f32_32x32x16_bf16 v[80:95], v[48:51], a[132:135], v[80:95]
    s_waitcnt lgkmcnt(10)
    ds_read_b64_tr_b16 v[60:61], v24 offset:4096
    ds_read_b64_tr_b16 v[62:63], v24 offset:4608
    v_mfma_f32_32x32x16_bf16 v[64:79], v[52:55], a[136:139], v[64:79]
    buffer_load_dwordx4 v11, s[12:15], s53 offen offset:1024 lds
    ds_read_b64_tr_b16 a[72:73], v25 offset:22528
    ds_read_b64_tr_b16 a[74:75], v25 offset:23552
    ds_read_b64_tr_b16 a[76:77], v26 offset:22528
    ds_read_b64_tr_b16 a[78:79], v26 offset:23552
    v_mfma_f32_32x32x16_bf16 v[80:95], v[52:55], a[140:143], v[80:95]
    s_waitcnt lgkmcnt(10)
    ds_read_b64_tr_b16 v[48:49], v21 offset:6144
    ds_read_b64_tr_b16 v[50:51], v21 offset:6656
    v_mfma_f32_32x32x16_bf16 v[64:79], v[56:59], a[144:147], v[64:79]
    buffer_load_dwordx4 v2, s[12:15], s53 offen offset:2048 lds
    v_mfma_f32_32x32x16_bf16 v[80:95], v[56:59], a[148:151], v[80:95]
    buffer_load_dwordx4 v3, s[12:15], s53 offen offset:3072 lds
    s_waitcnt lgkmcnt(6)
    ds_read_b64_tr_b16 v[52:53], v22 offset:6144
    ds_read_b64_tr_b16 v[54:55], v22 offset:6656
    v_mfma_f32_32x32x16_bf16 v[64:79], v[60:63], a[152:155], v[64:79]
    s_add_u32 m0, s36, 28672
    s_add_u32 s53, s31, 65536
    buffer_load_dwordx4 v10, s[12:15], s53 offen lds
    v_mfma_f32_32x32x16_bf16 v[80:95], v[60:63], a[156:159], v[80:95]
    s_waitcnt lgkmcnt(2)
    ds_read_b64_tr_b16 v[56:57], v23 offset:6144
    ds_read_b64_tr_b16 v[58:59], v23 offset:6656
    v_mfma_f32_32x32x16_bf16 v[64:79], v[48:51], a[160:163], v[64:79]
    buffer_load_dwordx4 v11, s[12:15], s53 offen offset:1024 lds
    v_mfma_f32_32x32x16_bf16 v[80:95], v[48:51], a[164:167], v[80:95]
    s_waitcnt lgkmcnt(2)
    ds_read_b64_tr_b16 v[60:61], v24 offset:6144
    ds_read_b64_tr_b16 v[62:63], v24 offset:6656
    v_mfma_f32_32x32x16_bf16 v[64:79], v[52:55], a[168:171], v[64:79]
    buffer_load_dwordx4 v2, s[12:15], s53 offen offset:2048 lds
    v_mfma_f32_32x32x16_bf16 v[80:95], v[52:55], a[172:175], v[80:95]
    s_waitcnt lgkmcnt(2)
    s_waitcnt vmcnt(11)
    s_barrier
    ds_read_b64_tr_b16 v[48:49], v21 offset:8192
    ds_read_b64_tr_b16 v[50:51], v21 offset:8704
    v_mfma_f32_32x32x16_bf16 v[64:79], v[56:59], a[176:179], v[64:79]
    buffer_load_dwordx4 v3, s[12:15], s53 offen offset:3072 lds
    v_mfma_f32_32x32x16_bf16 v[80:95], v[56:59], a[180:183], v[80:95]
    s_add_u32 m0, s36, 24576
    s_add_u32 s53, s40, 131072
    buffer_load_dwordx4 v10, s[12:15], s53 offen lds
    s_waitcnt lgkmcnt(2)
    ds_read_b64_tr_b16 v[52:53], v22 offset:8192
    ds_read_b64_tr_b16 v[54:55], v22 offset:8704
    v_mfma_f32_32x32x16_bf16 v[64:79], v[60:63], a[184:187], v[64:79]
    buffer_load_dwordx4 v11, s[12:15], s53 offen offset:1024 lds
    v_mfma_f32_32x32x16_bf16 v[80:95], v[60:63], a[188:191], v[80:95]
    s_waitcnt lgkmcnt(2)
    ds_read_b64_tr_b16 v[56:57], v23 offset:8192
    ds_read_b64_tr_b16 v[58:59], v23 offset:8704
    v_mfma_f32_32x32x16_bf16 v[64:79], v[48:51], a[192:195], v[64:79]
    buffer_load_dwordx4 v2, s[12:15], s53 offen offset:2048 lds
    v_mfma_f32_32x32x16_bf16 v[80:95], v[48:51], a[196:199], v[80:95]
    s_waitcnt lgkmcnt(2)
    ds_read_b64_tr_b16 v[60:61], v24 offset:8192
    ds_read_b64_tr_b16 v[62:63], v24 offset:8704
    v_mfma_f32_32x32x16_bf16 v[64:79], v[52:55], a[200:203], v[64:79]
    buffer_load_dwordx4 v3, s[12:15], s53 offen offset:3072 lds
    v_mfma_f32_32x32x16_bf16 v[80:95], v[52:55], a[204:207], v[80:95]
    v_lshlrev_b32 v37, 3, v1
    buffer_load_dwordx2 v[38:39], v37, s[20:23], s33 offen sc1
    s_waitcnt lgkmcnt(2)
    ds_read_b64_tr_b16 v[48:49], v21 offset:10240
    ds_read_b64_tr_b16 v[50:51], v21 offset:10752
    v_mfma_f32_32x32x16_bf16 v[64:79], v[56:59], a[208:211], v[64:79]
    s_add_u32 m0, s36, 20480
    s_add_u32 s53, s41, 131072
    buffer_load_dwordx4 v10, s[12:15], s53 offen lds
    s_waitcnt vmcnt(16)
    ds_read_b64_tr_b16 a[80:81], v25 offset:36864
    ds_read_b64_tr_b16 a[82:83], v25 offset:37888
    ds_read_b64_tr_b16 a[84:85], v26 offset:36864
    ds_read_b64_tr_b16 a[86:87], v26 offset:37888
    v_mfma_f32_32x32x16_bf16 v[80:95], v[56:59], a[212:215], v[80:95]
    buffer_load_dwordx4 v11, s[12:15], s53 offen offset:1024 lds
    s_waitcnt lgkmcnt(6)
    ds_read_b64_tr_b16 v[52:53], v22 offset:10240
    ds_read_b64_tr_b16 v[54:55], v22 offset:10752
    v_mfma_f32_32x32x16_bf16 v[64:79], v[60:63], a[216:219], v[64:79]
    buffer_load_dwordx4 v2, s[12:15], s53 offen offset:2048 lds
    s_waitcnt vmcnt(16)
    ds_read_b64_tr_b16 a[88:89], v25 offset:38912
    ds_read_b64_tr_b16 a[90:91], v25 offset:39936
    ds_read_b64_tr_b16 a[92:93], v26 offset:38912
    ds_read_b64_tr_b16 a[94:95], v26 offset:39936
    v_mfma_f32_32x32x16_bf16 v[80:95], v[60:63], a[220:223], v[80:95]
    buffer_load_dwordx2 v[30:31], v32, s[20:23], 0 offen offset:32 sc1
    s_waitcnt lgkmcnt(10)
    ds_read_b64_tr_b16 v[56:57], v23 offset:10240
    ds_read_b64_tr_b16 v[58:59], v23 offset:10752
    v_mfma_f32_32x32x16_bf16 v[64:79], v[48:51], a[224:227], v[64:79]
    buffer_load_dwordx4 v3, s[12:15], s53 offen offset:3072 lds
    s_waitcnt vmcnt(16)
    ds_read_b64_tr_b16 a[96:97], v25 offset:32768
    ds_read_b64_tr_b16 a[98:99], v25 offset:33792
    ds_read_b64_tr_b16 a[100:101], v26 offset:32768
    ds_read_b64_tr_b16 a[102:103], v26 offset:33792
    v_mfma_f32_32x32x16_bf16 v[80:95], v[48:51], a[228:231], v[80:95]
    s_waitcnt lgkmcnt(10)
    ds_read_b64_tr_b16 v[60:61], v24 offset:10240
    ds_read_b64_tr_b16 v[62:63], v24 offset:10752
    v_mfma_f32_32x32x16_bf16 v[64:79], v[52:55], a[232:235], v[64:79]
    s_add_u32 m0, s36, 16384
    s_nop 0
    buffer_load_dwordx4 v10, s[12:15], s42 offen lds
    v_mfma_f32_32x32x16_bf16 v[80:95], v[52:55], a[236:239], v[80:95]
    s_waitcnt lgkmcnt(6)
    v_mfma_f32_32x32x16_bf16 v[64:79], v[56:59], a[240:243], v[64:79]
    buffer_load_dwordx4 v11, s[12:15], s42 offen offset:1024 lds
    s_waitcnt vmcnt(16)
    ds_read_b64_tr_b16 a[104:105], v25 offset:34816
    ds_read_b64_tr_b16 a[106:107], v25 offset:35840
    ds_read_b64_tr_b16 a[108:109], v26 offset:34816
    ds_read_b64_tr_b16 a[110:111], v26 offset:35840
    v_mfma_f32_32x32x16_bf16 v[80:95], v[56:59], a[244:247], v[80:95]
    buffer_load_dwordx4 v2, s[12:15], s42 offen offset:2048 lds
    s_waitcnt lgkmcnt(4)
    v_mfma_f32_32x32x16_bf16 v[64:79], v[60:63], a[248:251], v[64:79]
    buffer_load_dwordx4 v3, s[12:15], s42 offen offset:3072 lds
    s_waitcnt vmcnt(16)
    ds_read_b64_tr_b16 a[112:113], v25 offset:28672
    ds_read_b64_tr_b16 a[114:115], v25 offset:29696
    ds_read_b64_tr_b16 a[116:117], v26 offset:28672
    ds_read_b64_tr_b16 a[118:119], v26 offset:29696
    v_mfma_f32_32x32x16_bf16 v[80:95], v[60:63], a[252:255], v[80:95]
    s_nop 11
    s_waitcnt vmcnt(9)
Q_pc_5:
    s_add_u32 s54, s51, 1
    v_subrev_u32 v34, s54, v38
    v_cmp_eq_u32 s[66:67], s52, v39
    v_cmp_ge_u32 vcc, 2, v34
    s_nop 1
    s_and_b64 vcc, vcc, s[66:67]
    s_cmp_eq_u64 vcc, -1
    s_cbranch_scc1 Q_pok_6
    s_add_u32 s63, s63, 1
    s_cmp_lt_u32 s63, 0x40000
    s_cbranch_scc0 L_end
    s_sleep 1
    buffer_load_dwordx2 v[38:39], v37, s[20:23], s33 offen sc1
    s_waitcnt vmcnt(0)
    s_branch Q_pc_5
Q_pok_6:
    v_lshrrev_b32 v37, 5, v1
    v_lshlrev_b32 v37, 4, v37
    v_and_b32 v38, 16, v1
    v_xor_b32 v38, 16, v38
    v_lshl_add_u32 v37, v38, 2, v37
    s_mov_b32 s76, 0x10001
    s_mov_b32 s77, 0x10001
    s_lshl_b32 s37, s75, 11
    s_add_u32 s37, s37, s62
    s_lshl_b32 s38, s75, 7
    s_add_u32 s38, s38, s62
    s_add_u32 s38, s38, 4096
    buffer_load_dwordx4 v[48:51], v27, s[20:23], s37 offen sc1
    buffer_load_dwordx4 v[52:55], v27, s[20:23], s37 offen offset:1024 sc1
    s_mov_b64 exec, s[76:77]
    buffer_load_dwordx4 v[56:59], v37, s[20:23], s38 offen sc1
    buffer_load_dwordx4 v[60:63], v37, s[20:23], s38 offen offset:32 sc1
    s_mov_b64 exec, -1
    s_waitcnt vmcnt(9)
    s_add_u32 s54, s51, 1
    v_subrev_u32 v34, s54, v30
    v_cmp_eq_u32 s[66:67], s52, v31
    v_cmp_ge_u32 vcc, 2, v34
    s_nop 1
    s_and_b64 vcc, vcc, s[66:67]
    s_cmp_eq_u64 vcc, -1
    s_cbranch_scc0 Q_slow_7
    v_pk_mul_f32 v[240:241], v[64:65], s[68:69]
    v_pk_mul_f32 v[242:243], v[66:67], s[68:69]
    v_pk_mul_f32 v[244:245], v[68:69], s[68:69]
    v_pk_mul_f32 v[246:247], v[70:71], s[68:69]
    v_exp_f32_e64 v240, v240 clamp
    v_exp_f32_e64 v242, v242 clamp
    v_exp_f32_e64 v244, v244 clamp
    v_exp_f32_e64 v246, v246 clamp
    v_exp_f32_e64 v241, v241 clamp
    v_exp_f32_e64 v243, v243 clamp
    buffer_load_dwordx4 v[192:195], v27, s[20:23], s4 offen sc1
    v_exp_f32_e64 v245, v245 clamp
    v_exp_f32_e64 v247, v247 clamp
    v_max_f32 v64, 0, v64
    v_max_f32 v66, 0, v66
    v_max_f32 v68, 0, v68
    v_max_f32 v70, 0, v70
    v_max_f32 v65, 0, v65
    v_max_f32 v67, 0, v67
    v_max_f32 v69, 0, v69
    v_max_f32 v71, 0, v71
    v_pk_add_f32 v[64:65], v[64:65], s[70:71]
    v_pk_add_f32 v[66:67], v[66:67], s[70:71]
    v_pk_add_f32 v[68:69], v[68:69], s[70:71]
    buffer_load_dwordx4 v[196:199], v27, s[20:23], s4 offen offset:1024 sc1
    v_pk_add_f32 v[70:71], v[70:71], s[70:71]
    v_pk_add_f32 v[240:241], v[240:241], v[64:65]
    v_pk_add_f32 v[242:243], v[242:243], v[66:67]
    v_pk_add_f32 v[244:245], v[244:245], v[68:69]
    v_pk_add_f32 v[246:247], v[246:247], v[70:71]
    v_cvt_pk_bf16_f32 v160, v240, v241
    v_cvt_pk_bf16_f32 v161, v242, v243
    v_cvt_pk_bf16_f32 v162, v244, v245
    v_cvt_pk_bf16_f32 v163, v246, v247
    v_pk_mul_f32 v[240:241], v[72:73], s[68:69]
    v_pk_mul_f32 v[242:243], v[74:75], s[68:69]
    v_pk_mul_f32 v[244:245], v[76:77], s[68:69]
    v_pk_mul_f32 v[246:247], v[78:79], s[68:69]
    v_exp_f32_e64 v240, v240 clamp
    buffer_load_dwordx4 v[200:203], v27, s[20:23], s4 offen offset:2048 sc1
    v_exp_f32_e64 v242, v242 clamp
    v_exp_f32_e64 v244, v244 clamp
    v_exp_f32_e64 v246, v246 clamp
    v_exp_f32_e64 v241, v241 clamp
    v_exp_f32_e64 v243, v243 clamp
    v_exp_f32_e64 v245, v245 clamp
    v_exp_f32_e64 v247, v247 clamp
    v_max_f32 v72, 0, v72
    buffer_load_dwordx4 v[204:207], v27, s[20:23], s4 offen offset:3072 sc1
    v_max_f32 v74, 0, v74
    v_max_f32 v76, 0, v76
    v_max_f32 v78, 0, v78
    v_max_f32 v73, 0, v73
    v_max_f32 v75, 0, v75
    v_max_f32 v77, 0, v77
    v_max_f32 v79, 0, v79
    v_pk_add_f32 v[72:73], v[72:73], s[70:71]
    v_pk_add_f32 v[74:75], v[74:75], s[70:71]
    v_pk_add_f32 v[76:77], v[76:77], s[70:71]
    v_pk_add_f32 v[78:79], v[78:79], s[70:71]
    v_pk_add_f32 v[240:241], v[240:241], v[72:73]
    v_pk_add_f32 v[242:243], v[242:243], v[74:75]
    v_pk_add_f32 v[244:245], v[244:245], v[76:77]
    v_pk_add_f32 v[246:247], v[246:247], v[78:79]
    buffer_load_dwordx4 v[208:211], v27, s[20:23], s5 offen sc1
    v_cvt_pk_bf16_f32 v164, v240, v241
    v_cvt_pk_bf16_f32 v165, v242, v243
    v_cvt_pk_bf16_f32 v166, v244, v245
    v_cvt_pk_bf16_f32 v167, v246, v247
    v_pk_mul_f32 v[240:241], v[80:81], s[68:69]
    v_pk_mul_f32 v[242:243], v[82:83], s[68:69]
    v_pk_mul_f32 v[244:245], v[84:85], s[68:69]
    v_pk_mul_f32 v[246:247], v[86:87], s[68:69]
    v_exp_f32_e64 v240, v240 clamp
    v_exp_f32_e64 v242, v242 clamp
    v_exp_f32_e64 v244, v244 clamp
    v_exp_f32_e64 v246, v246 clamp
    buffer_load_dwordx4 v[212:215], v27, s[20:23], s5 offen offset:1024 sc1
    v_exp_f32_e64 v241, v241 clamp
    v_exp_f32_e64 v243, v243 clamp
    v_exp_f32_e64 v245, v245 clamp
    v_exp_f32_e64 v247, v247 clamp
    v_max_f32 v80, 0, v80
    v_max_f32 v82, 0, v82
    v_max_f32 v84, 0, v84
    v_max_f32 v86, 0, v86
    v_max_f32 v81, 0, v81
    v_max_f32 v83, 0, v83
    v_max_f32 v85, 0, v85
    buffer_load_dwordx4 v[216:219], v27, s[20:23], s5 offen offset:2048 sc1
    v_max_f32 v87, 0, v87
    v_pk_add_f32 v[80:81], v[80:81], s[70:71]
    v_pk_add_f32 v[82:83], v[82:83], s[70:71]
    v_pk_add_f32 v[84:85], v[84:85], s[70:71]
    v_pk_add_f32 v[86:87], v[86:87], s[70:71]
    v_pk_add_f32 v[240:241], v[240:241], v[80:81]
    v_pk_add_f32 v[242:243], v[242:243], v[82:83]
    v_pk_add_f32 v[244:245], v[244:245], v[84:85]
    v_pk_add_f32 v[246:247], v[246:247], v[86:87]
    v_cvt_pk_bf16_f32 v168, v240, v241
    v_cvt_pk_bf16_f32 v169, v242, v243
    v_cvt_pk_bf16_f32 v170, v244, v245
    v_cvt_pk_bf16_f32 v171, v246, v247
    v_pk_mul_f32 v[240:241], v[88:89], s[68:69]
    v_pk_mul_f32 v[242:243], v[90:91], s[68:69]
    buffer_load_dwordx4 v[220:223], v27, s[20:23], s5 offen offset:3072 sc1
    v_pk_mul_f32 v[244:245], v[92:93], s[68:69]
    v_pk_mul_f32 v[246:247], v[94:95], s[68:69]
    v_exp_f32_e64 v240, v240 clamp
    v_exp_f32_e64 v242, v242 clamp
    v_exp_f32_e64 v244, v244 clamp
    v_exp_f32_e64 v246, v246 clamp
    v_exp_f32_e64 v241, v241 clamp
    v_exp_f32_e64 v243, v243 clamp
    v_exp_f32_e64 v245, v245 clamp
    buffer_load_dwordx4 v[224:227], v27, s[20:23], s6 offen sc1
    v_exp_f32_e64 v247, v247 clamp
    v_max_f32 v88, 0, v88
    v_max_f32 v90, 0, v90
    v_max_f32 v92, 0, v92
    v_max_f32 v94, 0, v94
    v_max_f32 v89, 0, v89
    v_max_f32 v91, 0, v91
    v_max_f32 v93, 0, v93
    v_max_f32 v95, 0, v95
    v_pk_add_f32 v[88:89], v[88:89], s[70:71]
    v_pk_add_f32 v[90:91], v[90:91], s[70:71]
    v_pk_add_f32 v[92:93], v[92:93], s[70:71]
    v_pk_add_f32 v[94:95], v[94:95], s[70:71]
    v_pk_add_f32 v[240:241], v[240:241], v[88:89]
    buffer_load_dwordx4 v[228:231], v27, s[20:23], s6 offen offset:1024 sc1
    v_pk_add_f32 v[242:243], v[242:243], v[90:91]
    v_pk_add_f32 v[244:245], v[244:245], v[92:93]
    v_pk_add_f32 v[246:247], v[246:247], v[94:95]
    v_cvt_pk_bf16_f32 v172, v240, v241
    v_cvt_pk_bf16_f32 v173, v242, v243
    v_cvt_pk_bf16_f32 v174, v244, v245
    v_cvt_pk_bf16_f32 v175, v246, v247
    s_waitcnt vmcnt(10)
    v_cvt_pk_bf16_f32 v63, v62, v63
    v_cvt_pk_bf16_f32 v62, v60, v61
    v_cvt_pk_bf16_f32 v61, v58, v59
    v_cvt_pk_bf16_f32 v60, v56, v57
    v_cvt_pk_bf16_f32 v59, v54, v55
    v_cvt_pk_bf16_f32 v58, v52, v53
    v_cvt_pk_bf16_f32 v57, v50, v51
    v_cvt_pk_bf16_f32 v56, v48, v49
    v_mov_b32_dpp v60, v60 row_newbcast:0 row_mask:0xf bank_mask:0xf
    v_mov_b32_dpp v61, v61 row_newbcast:0 row_mask:0xf bank_mask:0xf
    v_mov_b32_dpp v62, v62 row_newbcast:0 row_mask:0xf bank_mask:0xf
    v_mov_b32_dpp v63, v63 row_newbcast:0 row_mask:0xf bank_mask:0xf
    v_cndmask_b32 v48, v56, v60, s[64:65]
    v_cndmask_b32 v52, v60, v56, s[64:65]
    v_cndmask_b32 v49, v57, v61, s[64:65]
    v_cndmask_b32 v53, v61, v57, s[64:65]
    v_cndmask_b32 v50, v58, v62, s[64:65]
    v_cndmask_b32 v54, v62, v58, s[64:65]
    buffer_load_dwordx4 v[232:235], v27, s[20:23], s6 offen offset:2048 sc1
    v_cndmask_b32 v51, v59, v63, s[64:65]
    v_cndmask_b32 v55, v63, v59, s[64:65]
    s_nop 1
    v_mfma_f32_32x32x16_bf16 v[96:111], v[48:51], v[160:163], 0
    v_mfma_f32_32x32x16_bf16 v[112:127], v[52:55], v[164:167], 0
    buffer_load_dwordx4 v[236:239], v27, s[20:23], s6 offen offset:3072 sc1
    v_mfma_f32_32x32x16_bf16 v[128:143], v[48:51], v[168:171], 0
    v_mfma_f32_32x32x16_bf16 v[144:159], v[52:55], v[172:175], 0
    s_add_u32 m0, s36, 36864
    s_lshl3_add_u32 s53, s73, s43
    buffer_load_dwordx4 v10, s[16:19], s53 offen lds
    s_nop 8
    v_add_f32 v104, s70, v104
    v_add_f32 v112, s70, v112
    v_add_f32 v136, s70, v136
    v_add_f32 v144, s70, v144
    v_rcp_f32 v104, v104
    buffer_load_dwordx4 v11, s[16:19], s53 offen offset:1024 lds
    v_rcp_f32 v112, v112
    v_rcp_f32 v136, v136
    v_rcp_f32 v144, v144
    v_mul_f32 v104, v104, v28
    v_mul_f32 v112, v112, v28
    v_mul_f32 v136, v136, v29
    v_mul_f32 v144, v144, v29
    v_pk_mul_f32 v[96:97], v[96:97], v[104:105] op_sel_hi:[1,0]
    v_pk_mul_f32 v[98:99], v[98:99], v[104:105] op_sel_hi:[1,0]
    v_pk_mul_f32 v[100:101], v[100:101], v[104:105] op_sel_hi:[1,0]
    v_pk_mul_f32 v[102:103], v[102:103], v[104:105] op_sel_hi:[1,0]
    v_cvt_pk_bf16_f32 v176, v96, v97
    buffer_load_dwordx4 v2, s[16:19], s53 offen offset:2048 lds
    v_cvt_pk_bf16_f32 v177, v98, v99
    v_cvt_pk_bf16_f32 v178, v100, v101
    v_cvt_pk_bf16_f32 v179, v102, v103
    buffer_store_dwordx4 v[176:179], v27, s[20:23], s48 offen sc1
    v_pk_mul_f32 v[120:121], v[120:121], v[112:113] op_sel_hi:[1,0]
    v_pk_mul_f32 v[122:123], v[122:123], v[112:113] op_sel_hi:[1,0]
    v_pk_mul_f32 v[124:125], v[124:125], v[112:113] op_sel_hi:[1,0]
    v_pk_mul_f32 v[126:127], v[126:127], v[112:113] op_sel_hi:[1,0]
    v_cvt_pk_bf16_f32 v180, v120, v121
    v_cvt_pk_bf16_f32 v181, v122, v123
    v_cvt_pk_bf16_f32 v182, v124, v125
    v_cvt_pk_bf16_f32 v183, v126, v127
    buffer_store_dwordx4 v[180:183], v27, s[20:23], s48 offen offset:2048 sc1
    v_pk_mul_f32 v[128:129], v[128:129], v[136:137] op_sel_hi:[1,0]
    v_pk_mul_f32 v[130:131], v[130:131], v[136:137] op_sel_hi:[1,0]
    v_pk_mul_f32 v[132:133], v[132:133], v[136:137] op_sel_hi:[1,0]
    v_pk_mul_f32 v[134:135], v[134:135], v[136:137] op_sel_hi:[1,0]
    v_cvt_pk_bf16_f32 v184, v128, v129
    v_cvt_pk_bf16_f32 v185, v130, v131
    v_cvt_pk_bf16_f32 v186, v132, v133
    v_cvt_pk_bf16_f32 v187, v134, v135
    buffer_store_dwordx4 v[184:187], v27, s[20:23], s49 offen sc1
    v_pk_mul_f32 v[152:153], v[152:153], v[144:145] op_sel_hi:[1,0]
    v_pk_mul_f32 v[154:155], v[154:155], v[144:145] op_sel_hi:[1,0]
    v_pk_mul_f32 v[156:157], v[156:157], v[144:145] op_sel_hi:[1,0]
    v_pk_mul_f32 v[158:159], v[158:159], v[144:145] op_sel_hi:[1,0]
    v_cvt_pk_bf16_f32 v188, v152, v153
    v_cvt_pk_bf16_f32 v189, v154, v155
    v_cvt_pk_bf16_f32 v190, v156, v157
    v_cvt_pk_bf16_f32 v191, v158, v159
    buffer_store_dwordx4 v[188:191], v27, s[20:23], s49 offen offset:2048 sc1
Q_join_8:
    buffer_load_dwordx2 v[30:31], v32, s[20:23], 0 offen offset:32 sc1
    s_barrier
    s_waitcnt vmcnt(18)
    v_mfma_f32_32x32x16_bf16 v[64:79], a[0:3], v[192:195], 0
    buffer_load_dwordx4 v[240:243], v27, s[20:23], s7 offen sc1
    v_mfma_f32_32x32x16_bf16 v[96:111], a[4:7], v[192:195], 0
    buffer_load_dwordx4 v3, s[16:19], s53 offen offset:3072 lds
    v_mfma_f32_32x32x16_bf16 v[80:95], a[0:3], v[196:199], 0
    buffer_load_dwordx4 v[244:247], v27, s[20:23], s7 offen offset:1024 sc1
    v_mfma_f32_32x32x16_bf16 v[112:127], a[4:7], v[196:199], 0
    ds_read_b64_tr_b16 a[120:121], v25 offset:30720
    ds_read_b64_tr_b16 a[122:123], v25 offset:31744
    ds_read_b64_tr_b16 a[124:125], v26 offset:30720
    ds_read_b64_tr_b16 a[126:127], v26 offset:31744
    s_waitcnt vmcnt(19)
    v_mfma_f32_32x32x16_bf16 v[64:79], a[8:11], v[200:203], v[64:79]
    buffer_load_dwordx4 v[248:251], v27, s[20:23], s7 offen offset:2048 sc1
    v_mfma_f32_32x32x16_bf16 v[96:111], a[12:15], v[200:203], v[96:111]
    s_add_u32 m0, s36, 12288
    s_lshl3_add_u32 s53, s74, s43
    buffer_load_dwordx4 v10, s[16:19], s53 offen lds
    v_mfma_f32_32x32x16_bf16 v[80:95], a[8:11], v[204:207], v[80:95]
    buffer_load_dwordx4 v[252:255], v27, s[20:23], s7 offen offset:3072 sc1
    v_mfma_f32_32x32x16_bf16 v[112:127], a[12:15], v[204:207], v[112:127]
    ds_read_b64_tr_b16 a[128:129], v25 offset:24576
    ds_read_b64_tr_b16 a[130:131], v25 offset:25600
    ds_read_b64_tr_b16 a[132:133], v26 offset:24576
    ds_read_b64_tr_b16 a[134:135], v26 offset:25600
    s_waitcnt vmcnt(7)
    s_add_u32 s54, s51, 1
    v_mov_b32 v34, s54
    v_mov_b32 v35, s52
    v_mov_b32 v36, 0
    s_mov_b64 exec, 1
    buffer_store_dwordx2 v[34:35], v36, s[20:23], s50 offen sc1
    s_mov_b64 exec, -1
    v_mfma_f32_32x32x16_bf16 v[64:79], a[16:19], v[208:211], v[64:79]
    buffer_load_dwordx4 v11, s[16:19], s53 offen offset:1024 lds
    v_mfma_f32_32x32x16_bf16 v[96:111], a[20:23], v[208:211], v[96:111]
    buffer_load_dwordx4 v2, s[16:19], s53 offen offset:2048 lds
    v_mfma_f32_32x32x16_bf16 v[80:95], a[16:19], v[212:215], v[80:95]
    buffer_load_dwordx4 v3, s[16:19], s53 offen offset:3072 lds
    v_mfma_f32_32x32x16_bf16 v[112:127], a[20:23], v[212:215], v[112:127]
    ds_read_b64_tr_b16 a[136:137], v25 offset:26624
    ds_read_b64_tr_b16 a[138:139], v25 offset:27648
    ds_read_b64_tr_b16 a[140:141], v26 offset:26624
    ds_read_b64_tr_b16 a[142:143], v26 offset:27648
    v_mfma_f32_32x32x16_bf16 v[64:79], a[24:27], v[216:219], v[64:79]
    s_waitcnt vmcnt(10)
Q_pc_9:
    s_add_u32 s54, s51, 2
    v_subrev_u32 v34, s54, v30
    v_cmp_eq_u32 s[66:67], s52, v31
    v_cmp_ge_u32 vcc, 1, v34
    s_nop 1
    s_and_b64 vcc, vcc, s[66:67]
    s_cmp_eq_u64 vcc, -1
    s_cbranch_scc1 Q_pok_10
    s_add_u32 s63, s63, 1
    s_cmp_lt_u32 s63, 0x40000
    s_cbranch_scc0 L_end
    s_sleep 1
    buffer_load_dwordx2 v[30:31], v32, s[20:23], 0 offen offset:32 sc1
    s_waitcnt vmcnt(0)
    s_branch Q_pc_9
Q_pok_10:
    s_add_u32 s39, s4, 8192
    buffer_load_dwordx4 v[192:195], v27, s[20:23], s39 offen sc1
    v_mfma_f32_32x32x16_bf16 v[96:111], a[28:31], v[216:219], v[96:111]
    s_add_u32 m0, s36, 8192
    s_lshl3_add_u32 s53, s78, s43
    buffer_load_dwordx4 v10, s[16:19], s53 offen lds
    v_mfma_f32_32x32x16_bf16 v[80:95], a[24:27], v[220:223], v[80:95]
    buffer_load_dwordx4 v[196:199], v27, s[20:23], s39 offen offset:1024 sc1
    v_mfma_f32_32x32x16_bf16 v[112:127], a[28:31], v[220:223], v[112:127]
    ds_read_b64_tr_b16 a[144:145], v25 offset:20480
    ds_read_b64_tr_b16 a[146:147], v25 offset:21504
    ds_read_b64_tr_b16 a[148:149], v26 offset:20480
    ds_read_b64_tr_b16 a[150:151], v26 offset:21504
    v_mfma_f32_32x32x16_bf16 v[64:79], a[32:35], v[224:227], v[64:79]
    s_add_u32 s39, s4, 8192
    buffer_load_dwordx4 v[200:203], v27, s[20:23], s39 offen offset:2048 sc1
    v_mfma_f32_32x32x16_bf16 v[96:111], a[36:39], v[224:227], v[96:111]
    buffer_load_dwordx4 v11, s[16:19], s53 offen offset:1024 lds
    v_mfma_f32_32x32x16_bf16 v[80:95], a[32:35], v[228:231], v[80:95]
    buffer_load_dwordx4 v[204:207], v27, s[20:23], s39 offen offset:3072 sc1
    v_mfma_f32_32x32x16_bf16 v[112:127], a[36:39], v[228:231], v[112:127]
    ds_read_b64_tr_b16 a[152:153], v25 offset:22528
    ds_read_b64_tr_b16 a[154:155], v25 offset:23552
    ds_read_b64_tr_b16 a[156:157], v26 offset:22528
    ds_read_b64_tr_b16 a[158:159], v26 offset:23552
    v_mfma_f32_32x32x16_bf16 v[64:79], a[40:43], v[232:235], v[64:79]
    s_add_u32 s39, s5, 8192
    buffer_load_dwordx4 v[208:211], v27, s[20:23], s39 offen sc1
    v_mfma_f32_32x32x16_bf16 v[96:111], a[44:47], v[232:235], v[96:111]
    buffer_load_dwordx4 v2, s[16:19], s53 offen offset:2048 lds
    v_mfma_f32_32x32x16_bf16 v[80:95], a[40:43], v[236:239], v[80:95]
    buffer_load_dwordx4 v[212:215], v27, s[20:23], s39 offen offset:1024 sc1
    v_mfma_f32_32x32x16_bf16 v[112:127], a[44:47], v[236:239], v[112:127]
    buffer_load_dwordx4 v3, s[16:19], s53 offen offset:3072 lds
    s_waitcnt vmcnt(17)
    v_mfma_f32_32x32x16_bf16 v[64:79], a[48:51], v[240:243], v[64:79]
    s_add_u32 s39, s5, 8192
    buffer_load_dwordx4 v[216:219], v27, s[20:23], s39 offen offset:2048 sc1
    v_mfma_f32_32x32x16_bf16 v[96:111], a[52:55], v[240:243], v[96:111]
    buffer_load_dwordx2 v[30:31], v32, s[20:23], 0 offen offset:32 sc1
    v_mfma_f32_32x32x16_bf16 v[80:95], a[48:51], v[244:247], v[80:95]
    buffer_load_dwordx4 v[220:223], v27, s[20:23], s39 offen offset:3072 sc1
    v_mfma_f32_32x32x16_bf16 v[112:127], a[52:55], v[244:247], v[112:127]
    ds_read_b64_tr_b16 a[160:161], v25 offset:16384
    ds_read_b64_tr_b16 a[162:163], v25 offset:17408
    ds_read_b64_tr_b16 a[164:165], v26 offset:16384
    ds_read_b64_tr_b16 a[166:167], v26 offset:17408
    s_waitcnt vmcnt(17)
    v_mfma_f32_32x32x16_bf16 v[64:79], a[56:59], v[248:251], v[64:79]
    s_add_u32 s39, s6, 8192
    buffer_load_dwordx4 v[224:227], v27, s[20:23], s39 offen sc1
    v_mfma_f32_32x32x16_bf16 v[96:111], a[60:63], v[248:251], v[96:111]
    s_add_u32 m0, s36, 4096
    s_lshl3_add_u32 s53, s61, s43
    buffer_load_dwordx4 v10, s[16:19], s53 offen lds
    v_mfma_f32_32x32x16_bf16 v[80:95], a[56:59], v[252:255], v[80:95]
    buffer_load_dwordx4 v[228:231], v27, s[20:23], s39 offen offset:1024 sc1
    v_mfma_f32_32x32x16_bf16 v[112:127], a[60:63], v[252:255], v[112:127]
    ds_read_b64_tr_b16 a[168:169], v25 offset:18432
    ds_read_b64_tr_b16 a[170:171], v25 offset:19456
    ds_read_b64_tr_b16 a[172:173], v26 offset:18432
    ds_read_b64_tr_b16 a[174:175], v26 offset:19456
    s_waitcnt vmcnt(13)
    v_mfma_f32_32x32x16_bf16 v[64:79], a[64:67], v[192:195], v[64:79]
    s_add_u32 s39, s6, 8192
    buffer_load_dwordx4 v[232:235], v27, s[20:23], s39 offen offset:2048 sc1
    v_mfma_f32_32x32x16_bf16 v[96:111], a[68:71], v[192:195], v[96:111]
    buffer_load_dwordx4 v11, s[16:19], s53 offen offset:1024 lds
    v_mfma_f32_32x32x16_bf16 v[80:95], a[64:67], v[196:199], v[80:95]
    buffer_load_dwordx4 v[236:239], v27, s[20:23], s39 offen offset:3072 sc1
    v_mfma_f32_32x32x16_bf16 v[112:127], a[68:71], v[196:199], v[112:127]
    ds_read_b64_tr_b16 a[176:177], v25 offset:36864
    ds_read_b64_tr_b16 a[178:179], v25 offset:37888
    ds_read_b64_tr_b16 a[180:181], v26 offset:36864
    ds_read_b64_tr_b16 a[182:183], v26 offset:37888
    s_waitcnt vmcnt(13)
    v_mfma_f32_32x32x16_bf16 v[64:79], a[72:75], v[200:203], v[64:79]
    s_add_u32 s39, s7, 8192
    buffer_load_dwordx4 v[240:243], v27, s[20:23], s39 offen sc1
    v_mfma_f32_32x32x16_bf16 v[96:111], a[76:79], v[200:203], v[96:111]
    buffer_load_dwordx4 v2, s[16:19], s53 offen offset:2048 lds
    v_mfma_f32_32x32x16_bf16 v[80:95], a[72:75], v[204:207], v[80:95]
    buffer_load_dwordx4 v[244:247], v27, s[20:23], s39 offen offset:1024 sc1
    v_mfma_f32_32x32x16_bf16 v[112:127], a[76:79], v[204:207], v[112:127]
    ds_read_b64_tr_b16 a[184:185], v25 offset:38912
    ds_read_b64_tr_b16 a[186:187], v25 offset:39936
    ds_read_b64_tr_b16 a[188:189], v26 offset:38912
    ds_read_b64_tr_b16 a[190:191], v26 offset:39936
    s_waitcnt vmcnt(13)
    v_mfma_f32_32x32x16_bf16 v[64:79], a[80:83], v[208:211], v[64:79]
    s_add_u32 s39, s7, 8192
    buffer_load_dwordx4 v[248:251], v27, s[20:23], s39 offen offset:2048 sc1
    v_mfma_f32_32x32x16_bf16 v[96:111], a[84:87], v[208:211], v[96:111]
    buffer_load_dwordx4 v3, s[16:19], s53 offen offset:3072 lds
    v_mfma_f32_32x32x16_bf16 v[80:95], a[80:83], v[212:215], v[80:95]
    buffer_load_dwordx4 v[252:255], v27, s[20:23], s39 offen offset:3072 sc1
    v_mfma_f32_32x32x16_bf16 v[112:127], a[84:87], v[212:215], v[112:127]
    ds_read_b64_tr_b16 a[192:193], v25 offset:12288
    ds_read_b64_tr_b16 a[194:195], v25 offset:13312
    ds_read_b64_tr_b16 a[196:197], v26 offset:12288
    ds_read_b64_tr_b16 a[198:199], v26 offset:13312
    s_waitcnt vmcnt(12)
    v_mfma_f32_32x32x16_bf16 v[64:79], a[88:91], v[216:219], v[64:79]
Q_pc_11:
    s_add_u32 s54, s51, 3
    v_subrev_u32 v34, s54, v30
    v_cmp_eq_u32 s[66:67], s52, v31
    v_cmp_ge_u32 vcc, 0, v34
    s_nop 1
    s_and_b64 vcc, vcc, s[66:67]
    s_cmp_eq_u64 vcc, -1
    s_cbranch_scc1 Q_pok_12
    s_add_u32 s63, s63, 1
    s_cmp_lt_u32 s63, 0x40000
    s_cbranch_scc0 L_end
    s_sleep 1
    buffer_load_dwordx2 v[30:31], v32, s[20:23], 0 offen offset:32 sc1
    s_waitcnt vmcnt(0)
    s_branch Q_pc_11
Q_pok_12:
    s_add_u32 s39, s44, 16384
    buffer_load_dwordx4 v[192:195], v27, s[20:23], s39 offen sc1
    v_mfma_f32_32x32x16_bf16 v[96:111], a[92:95], v[216:219], v[96:111]
    ds_read_b64_tr_b16 a[200:201], v25 offset:14336
    ds_read_b64_tr_b16 a[202:203], v25 offset:15360
    ds_read_b64_tr_b16 a[204:205], v26 offset:14336
    ds_read_b64_tr_b16 a[206:207], v26 offset:15360
    v_mfma_f32_32x32x16_bf16 v[80:95], a[88:91], v[220:223], v[80:95]
    buffer_load_dwordx4 v[196:199], v27, s[20:23], s39 offen offset:1024 sc1
    v_mfma_f32_32x32x16_bf16 v[112:127], a[92:95], v[220:223], v[112:127]
    ds_read_b64_tr_b16 a[208:209], v25 offset:8192
    ds_read_b64_tr_b16 a[210:211], v25 offset:9216
    ds_read_b64_tr_b16 a[212:213], v26 offset:8192
    ds_read_b64_tr_b16 a[214:215], v26 offset:9216
    s_waitcnt vmcnt(11)
    v_mfma_f32_32x32x16_bf16 v[64:79], a[96:99], v[224:227], v[64:79]
    s_add_u32 s39, s44, 16384
    buffer_load_dwordx4 v[200:203], v27, s[20:23], s39 offen offset:2048 sc1
    v_mfma_f32_32x32x16_bf16 v[96:111], a[100:103], v[224:227], v[96:111]
    buffer_load_dwordx2 v[30:31], v32, s[20:23], 0 offen sc1
    v_mfma_f32_32x32x16_bf16 v[80:95], a[96:99], v[228:231], v[80:95]
    buffer_load_dwordx4 v[204:207], v27, s[20:23], s39 offen offset:3072 sc1
    v_mfma_f32_32x32x16_bf16 v[112:127], a[100:103], v[228:231], v[112:127]
    ds_read_b64_tr_b16 a[216:217], v25 offset:10240
    ds_read_b64_tr_b16 a[218:219], v25 offset:11264
    ds_read_b64_tr_b16 a[220:221], v26 offset:10240
    ds_read_b64_tr_b16 a[222:223], v26 offset:11264
    s_waitcnt vmcnt(11) lgkmcnt(14)
    v_mfma_f32_32x32x16_bf16 v[64:79], a[104:107], v[232:235], v[64:79]
    s_add_u32 s39, s45, 16384
    buffer_load_dwordx4 v[208:211], v27, s[20:23], s39 offen sc1
    v_mfma_f32_32x32x16_bf16 v[96:111], a[108:111], v[232:235], v[96:111]
    ds_read_b64_tr_b16 a[224:225], v25 offset:4096
    ds_read_b64_tr_b16 a[226:227], v25 offset:5120
    ds_read_b64_tr_b16 a[228:229], v26 offset:4096
    ds_read_b64_tr_b16 a[230:231], v26 offset:5120
    v_mfma_f32_32x32x16_bf16 v[80:95], a[104:107], v[236:239], v[80:95]
    buffer_load_dwordx4 v[212:215], v27, s[20:23], s39 offen offset:1024 sc1
    v_mfma_f32_32x32x16_bf16 v[112:127], a[108:111], v[236:239], v[112:127]
    s_waitcnt vmcnt(10)
    v_mfma_f32_32x32x16_bf16 v[64:79], a[112:115], v[240:243], v[64:79]
    s_add_u32 s39, s45, 16384
    buffer_load_dwordx4 v[216:219], v27, s[20:23], s39 offen offset:2048 sc1
    v_mfma_f32_32x32x16_bf16 v[96:111], a[116:119], v[240:243], v[96:111]
    v_mfma_f32_32x32x16_bf16 v[80:95], a[112:115], v[244:247], v[80:95]
    buffer_load_dwordx4 v[220:223], v27, s[20:23], s39 offen offset:3072 sc1
    v_mfma_f32_32x32x16_bf16 v[112:127], a[116:119], v[244:247], v[112:127]
    s_waitcnt vmcnt(9)
    v_mfma_f32_32x32x16_bf16 v[64:79], a[120:123], v[248:251], v[64:79]
    buffer_load_dwordx4 v[224:227], v27, s[20:23], s46 offen sc1
    v_mfma_f32_32x32x16_bf16 v[96:111], a[124:127], v[248:251], v[96:111]
    ds_read_b64_tr_b16 a[232:233], v25 offset:6144
    ds_read_b64_tr_b16 a[234:235], v25 offset:7168
    ds_read_b64_tr_b16 a[236:237], v26 offset:6144
    ds_read_b64_tr_b16 a[238:239], v26 offset:7168
    v_mfma_f32_32x32x16_bf16 v[80:95], a[120:123], v[252:255], v[80:95]
    buffer_load_dwordx4 v[228:231], v27, s[20:23], s46 offen offset:1024 sc1
    v_mfma_f32_32x32x16_bf16 v[112:127], a[124:127], v[252:255], v[112:127]
    s_waitcnt vmcnt(9)
    v_mfma_f32_32x32x16_bf16 v[64:79], a[128:131], v[192:195], v[64:79]
    buffer_load_dwordx4 v[232:235], v27, s[20:23], s46 offen offset:2048 sc1
    v_mfma_f32_32x32x16_bf16 v[96:111], a[132:135], v[192:195], v[96:111]
    v_mfma_f32_32x32x16_bf16 v[80:95], a[128:131], v[196:199], v[80:95]
    buffer_load_dwordx4 v[236:239], v27, s[20:23], s46 offen offset:3072 sc1
    v_mfma_f32_32x32x16_bf16 v[112:127], a[132:135], v[196:199], v[112:127]
    s_waitcnt vmcnt(8)
    v_mfma_f32_32x32x16_bf16 v[64:79], a[136:139], v[200:203], v[64:79]
Q_pc_13:
    s_add_u32 s54, s51, 1
    v_subrev_u32 v34, s54, v30
    v_cmp_eq_u32 s[66:67], s52, v31
    v_cmp_ge_u32 vcc, 2, v34
    s_nop 1
    s_and_b64 vcc, vcc, s[66:67]
    s_cmp_eq_u64 vcc, -1
    s_cbranch_scc1 Q_pok_14
    s_add_u32 s63, s63, 1
    s_cmp_lt_u32 s63, 0x40000
    s_cbranch_scc0 L_end
    s_sleep 1
    buffer_load_dwordx2 v[30:31], v32, s[20:23], 0 offen sc1
    s_waitcnt vmcnt(0)
    s_branch Q_pc_13
Q_pok_14:
    s_add_u32 s39, s73, s47
    buffer_load_dwordx4 v[240:243], v27, s[20:23], s39 offen sc1
    v_mfma_f32_32x32x16_bf16 v[96:111], a[140:143], v[200:203], v[96:111]
    v_mfma_f32_32x32x16_bf16 v[80:95], a[136:139], v[204:207], v[80:95]
    buffer_load_dwordx4 v[244:247], v27, s[20:23], s39 offen offset:1024 sc1
    v_mfma_f32_32x32x16_bf16 v[112:127], a[140:143], v[204:207], v[112:127]
    s_waitcnt vmcnt(8)
    v_mfma_f32_32x32x16_bf16 v[64:79], a[144:147], v[208:211], v[64:79]
    s_add_u32 s39, s73, s47
    buffer_load_dwordx4 v[248:251], v27, s[20:23], s39 offen offset:2048 sc1
    v_mfma_f32_32x32x16_bf16 v[96:111], a[148:151], v[208:211], v[96:111]
    v_mfma_f32_32x32x16_bf16 v[80:95], a[144:147], v[212:215], v[80:95]
    buffer_load_dwordx4 v[252:255], v27, s[20:23], s39 offen offset:3072 sc1
    v_mfma_f32_32x32x16_bf16 v[112:127], a[148:151], v[212:215], v[112:127]
    s_waitcnt vmcnt(8)
    v_mfma_f32_32x32x16_bf16 v[64:79], a[152:155], v[216:219], v[64:79]
    s_add_u32 s39, s74, s47
    buffer_load_dwordx4 v[192:195], v27, s[20:23], s39 offen sc1
    v_mfma_f32_32x32x16_bf16 v[96:111], a[156:159], v[216:219], v[96:111]
    v_mfma_f32_32x32x16_bf16 v[80:95], a[152:155], v[220:223], v[80:95]
    buffer_load_dwordx4 v[196:199], v27, s[20:23], s39 offen offset:1024 sc1
    v_mfma_f32_32x32x16_bf16 v[112:127], a[156:159], v[220:223], v[112:127]
    s_waitcnt vmcnt(8)
    v_mfma_f32_32x32x16_bf16 v[64:79], a[160:163], v[224:227], v[64:79]
    s_add_u32 s39, s74, s47
    buffer_load_dwordx4 v[200:203], v27, s[20:23], s39 offen offset:2048 sc1
    v_mfma_f32_32x32x16_bf16 v[96:111], a[164:167], v[224:227], v[96:111]
    v_mfma_f32_32x32x16_bf16 v[80:95], a[160:163], v[228:231], v[80:95]
    buffer_load_dwordx4 v[204:207], v27, s[20:23], s39 offen offset:3072 sc1
    v_mfma_f32_32x32x16_bf16 v[112:127], a[164:167], v[228:231], v[112:127]
    s_waitcnt vmcnt(8)
    v_mfma_f32_32x32x16_bf16 v[64:79], a[168:171], v[232:235], v[64:79]
    s_add_u32 s39, s78, s47
    buffer_load_dwordx4 v[208:211], v27, s[20:23], s39 offen sc1
    v_mfma_f32_32x32x16_bf16 v[96:111], a[172:175], v[232:235], v[96:111]
    v_mfma_f32_32x32x16_bf16 v[80:95], a[168:171], v[236:239], v[80:95]
    buffer_load_dwordx4 v[212:215], v27, s[20:23], s39 offen offset:1024 sc1
    v_mfma_f32_32x32x16_bf16 v[112:127], a[172:175], v[236:239], v[112:127]
    s_waitcnt vmcnt(8)
    v_mfma_f32_32x32x16_bf16 v[64:79], a[176:179], v[240:243], v[64:79]
    s_add_u32 s39, s78, s47
    buffer_load_dwordx4 v[216:219], v27, s[20:23], s39 offen offset:2048 sc1
    v_mfma_f32_32x32x16_bf16 v[96:111], a[180:183], v[240:243], v[96:111]
    v_mfma_f32_32x32x16_bf16 v[80:95], a[176:179], v[244:247], v[80:95]
    buffer_load_dwordx4 v[220:223], v27, s[20:23], s39 offen offset:3072 sc1
    v_mfma_f32_32x32x16_bf16 v[112:127], a[180:183], v[244:247], v[112:127]
    s_waitcnt vmcnt(8)
    v_mfma_f32_32x32x16_bf16 v[64:79], a[184:187], v[248:251], v[64:79]
    s_add_u32 s39, s61, s47
    buffer_load_dwordx4 v[224:227], v27, s[20:23], s39 offen sc1
    v_mfma_f32_32x32x16_bf16 v[96:111], a[188:191], v[248:251], v[96:111]
    v_mfma_f32_32x32x16_bf16 v[80:95], a[184:187], v[252:255], v[80:95]
    buffer_load_dwordx4 v[228:231], v27, s[20:23], s39 offen offset:1024 sc1
    v_mfma_f32_32x32x16_bf16 v[112:127], a[188:191], v[252:255], v[112:127]
    s_waitcnt vmcnt(8) lgkmcnt(14)
    v_mfma_f32_32x32x16_bf16 v[64:79], a[192:195], v[192:195], v[64:79]
    s_add_u32 s39, s61, s47
    buffer_load_dwordx4 v[232:235], v27, s[20:23], s39 offen offset:2048 sc1
    v_mfma_f32_32x32x16_bf16 v[96:111], a[196:199], v[192:195], v[96:111]
    v_mfma_f32_32x32x16_bf16 v[80:95], a[192:195], v[196:199], v[80:95]
    buffer_load_dwordx4 v[236:239], v27, s[20:23], s39 offen offset:3072 sc1
    v_mfma_f32_32x32x16_bf16 v[112:127], a[196:199], v[196:199], v[112:127]
    s_waitcnt vmcnt(8)
    v_mfma_f32_32x32x16_bf16 v[64:79], a[200:203], v[200:203], v[64:79]
    v_mfma_f32_32x32x16_bf16 v[96:111], a[204:207], v[200:203], v[96:111]
    v_mfma_f32_32x32x16_bf16 v[80:95], a[200:203], v[204:207], v[80:95]
    v_mfma_f32_32x32x16_bf16 v[112:127], a[204:207], v[204:207], v[112:127]
    s_waitcnt vmcnt(6) lgkmcnt(12)
    v_mfma_f32_32x32x16_bf16 v[64:79], a[208:211], v[208:211], v[64:79]
    v_and_b32 v21, 31, v1
    v_lshrrev_b32 v22, 5, v1
    v_mul_u32_u24 v21, 272, v21
    v_lshl_add_u32 v21, v22, 4, v21
    v_add_u32 v21, s36, v21
    v_mfma_f32_32x32x16_bf16 v[96:111], a[212:215], v[208:211], v[96:111]
    v_bfe_u32 v22, v1, 2, 3
    v_bcnt_u32_b32 v23, v22, 0
    v_and_b32 v23, 1, v23
    v_lshrrev_b32 v22, 2, v22
    v_lshl_add_u32 v22, v23, 1, v22
    v_mfma_f32_32x32x16_bf16 v[80:95], a[208:211], v[212:215], v[80:95]
    v_lshrrev_b32 v23, 5, v1
    v_lshl_add_u32 v22, v23, 2, v22
    v_bfe_u32 v23, v1, 3, 1
    v_and_b32 v24, 3, v1
    v_lshl_add_u32 v23, v23, 2, v24
    v_mfma_f32_32x32x16_bf16 v[112:127], a[212:215], v[212:215], v[112:127]
    v_lshlrev_b32 v24, 10, v22
    v_lshl_add_u32 v24, v23, 4, v24
    v_mul_u32_u24 v22, 272, v22
    v_lshl_add_u32 v22, v23, 5, v22
    s_mul_i32 s50, s3, 4352
    s_waitcnt vmcnt(4) lgkmcnt(8)
    v_mfma_f32_32x32x16_bf16 v[64:79], a[216:219], v[216:219], v[64:79]
    v_add_u32 v22, s50, v22
    v_add_u32 v23, 81920, v22
    s_add_u32 s50, s32, 8192
    v_mfma_f32_32x32x16_bf16 v[96:111], a[220:223], v[216:219], v[96:111]
    v_mfma_f32_32x32x16_bf16 v[80:95], a[216:219], v[220:223], v[80:95]
    v_mfma_f32_32x32x16_bf16 v[112:127], a[220:223], v[220:223], v[112:127]
    s_waitcnt vmcnt(2) lgkmcnt(4)
    v_mfma_f32_32x32x16_bf16 v[64:79], a[224:227], v[224:227], v[64:79]
    v_mfma_f32_32x32x16_bf16 v[96:111], a[228:231], v[224:227], v[96:111]
    v_mfma_f32_32x32x16_bf16 v[80:95], a[224:227], v[228:231], v[80:95]
    v_mfma_f32_32x32x16_bf16 v[112:127], a[228:231], v[228:231], v[112:127]
    s_waitcnt vmcnt(0) lgkmcnt(0)
    v_mfma_f32_32x32x16_bf16 v[64:79], a[232:235], v[232:235], v[64:79]
    v_mfma_f32_32x32x16_bf16 v[96:111], a[236:239], v[232:235], v[96:111]
    v_mfma_f32_32x32x16_bf16 v[80:95], a[232:235], v[236:239], v[80:95]
    v_mfma_f32_32x32x16_bf16 v[112:127], a[236:239], v[236:239], v[112:127]
    s_nop 8
    ds_write_b128 v21, v[64:67] offset:0
    ds_write_b128 v21, v[68:71] offset:32
    ds_write_b128 v21, v[72:75] offset:64
    ds_write_b128 v21, v[76:79] offset:96
    ds_write_b128 v21, v[96:99] offset:128
    ds_write_b128 v21, v[100:103] offset:160
    ds_write_b128 v21, v[104:107] offset:192
    ds_write_b128 v21, v[108:111] offset:224
    ds_write_b128 v21, v[80:83] offset:8704
    ds_write_b128 v21, v[84:87] offset:8736
    ds_write_b128 v21, v[88:91] offset:8768
    ds_write_b128 v21, v[92:95] offset:8800
    ds_write_b128 v21, v[112:115] offset:8832
    ds_write_b128 v21, v[116:119] offset:8864
    ds_write_b128 v21, v[120:123] offset:8896
    ds_write_b128 v21, v[124:127] offset:8928
    s_waitcnt lgkmcnt(0)
    s_barrier
    ds_read_b128 v[128:131], v22 offset:0
    ds_read_b128 v[132:135], v22 offset:16
    ds_read_b128 v[136:139], v22 offset:40960
    ds_read_b128 v[140:143], v22 offset:40976
    ds_read_b128 v[144:147], v23 offset:0
    ds_read_b128 v[148:151], v23 offset:16
    ds_read_b128 v[152:155], v23 offset:40960
    ds_read_b128 v[156:159], v23 offset:40976
    ds_read_b128 v[160:163], v22 offset:2176
    ds_read_b128 v[164:167], v22 offset:2192
    ds_read_b128 v[168:171], v22 offset:43136
    ds_read_b128 v[172:175], v22 offset:43152
    ds_read_b128 v[176:179], v23 offset:2176
    ds_read_b128 v[180:183], v23 offset:2192
    ds_read_b128 v[184:187], v23 offset:43136
    ds_read_b128 v[188:191], v23 offset:43152
    s_waitcnt lgkmcnt(8)
    v_pk_add_f32 v[128:129], v[128:129], v[136:137]
    v_pk_add_f32 v[144:145], v[144:145], v[152:153]
    v_pk_add_f32 v[130:131], v[130:131], v[138:139]
    v_pk_add_f32 v[146:147], v[146:147], v[154:155]
    v_pk_add_f32 v[132:133], v[132:133], v[140:141]
    v_pk_add_f32 v[148:149], v[148:149], v[156:157]
    v_pk_add_f32 v[134:135], v[134:135], v[142:143]
    v_pk_add_f32 v[150:151], v[150:151], v[158:159]
    v_pk_add_f32 v[128:129], v[128:129], v[144:145]
    v_pk_add_f32 v[130:131], v[130:131], v[146:147]
    v_pk_add_f32 v[132:133], v[132:133], v[148:149]
    v_pk_add_f32 v[134:135], v[134:135], v[150:151]
    v_cvt_pk_bf16_f32 v128, v128, v129
    v_cvt_pk_bf16_f32 v129, v130, v131
    v_cvt_pk_bf16_f32 v130, v132, v133
    v_cvt_pk_bf16_f32 v131, v134, v135
    buffer_store_dwordx4 v[128:131], v24, s[24:27], s32 offen
    s_waitcnt lgkmcnt(0)
    v_pk_add_f32 v[160:161], v[160:161], v[168:169]
    v_pk_add_f32 v[176:177], v[176:177], v[184:185]
    v_pk_add_f32 v[162:163], v[162:163], v[170:171]
    v_pk_add_f32 v[178:179], v[178:179], v[186:187]
    v_pk_add_f32 v[164:165], v[164:165], v[172:173]
    v_pk_add_f32 v[180:181], v[180:181], v[188:189]
    v_pk_add_f32 v[166:167], v[166:167], v[174:175]
    v_pk_add_f32 v[182:183], v[182:183], v[190:191]
    v_pk_add_f32 v[160:161], v[160:161], v[176:177]
    v_pk_add_f32 v[162:163], v[162:163], v[178:179]
    v_pk_add_f32 v[164:165], v[164:165], v[180:181]
    v_pk_add_f32 v[166:167], v[166:167], v[182:183]
    v_cvt_pk_bf16_f32 v160, v160, v161
    v_cvt_pk_bf16_f32 v161, v162, v163
    v_cvt_pk_bf16_f32 v162, v164, v165
    v_cvt_pk_bf16_f32 v163, v166, v167
    buffer_store_dwordx4 v[160:163], v24, s[24:27], s50 offen
    s_endpgm
Q_slow_7:
    v_pk_mul_f32 v[240:241], v[64:65], s[68:69]
    v_pk_mul_f32 v[242:243], v[66:67], s[68:69]
    v_pk_mul_f32 v[244:245], v[68:69], s[68:69]
    v_pk_mul_f32 v[246:247], v[70:71], s[68:69]
    v_exp_f32_e64 v240, v240 clamp
    v_exp_f32_e64 v242, v242 clamp
    v_exp_f32_e64 v244, v244 clamp
    v_exp_f32_e64 v246, v246 clamp
    v_exp_f32_e64 v241, v241 clamp
    v_exp_f32_e64 v243, v243 clamp
    v_exp_f32_e64 v245, v245 clamp
    v_exp_f32_e64 v247, v247 clamp
    v_max_f32 v64, 0, v64
    v_max_f32 v66, 0, v66
    v_max_f32 v68, 0, v68
    v_max_f32 v70, 0, v70
    v_max_f32 v65, 0, v65
    v_max_f32 v67, 0, v67
    v_max_f32 v69, 0, v69
    v_max_f32 v71, 0, v71
    v_pk_add_f32 v[64:65], v[64:65], s[70:71]
    v_pk_add_f32 v[66:67], v[66:67], s[70:71]
    v_pk_add_f32 v[68:69], v[68:69], s[70:71]
    v_pk_add_f32 v[70:71], v[70:71], s[70:71]
    v_pk_add_f32 v[240:241], v[240:241], v[64:65]
    v_pk_add_f32 v[242:243], v[242:243], v[66:67]
    v_pk_add_f32 v[244:245], v[244:245], v[68:69]
    v_pk_add_f32 v[246:247], v[246:247], v[70:71]
    v_cvt_pk_bf16_f32 v160, v240, v241
    v_cvt_pk_bf16_f32 v161, v242, v243
    v_cvt_pk_bf16_f32 v162, v244, v245
    v_cvt_pk_bf16_f32 v163, v246, v247
    v_pk_mul_f32 v[240:241], v[72:73], s[68:69]
    v_pk_mul_f32 v[242:243], v[74:75], s[68:69]
    v_pk_mul_f32 v[244:245], v[76:77], s[68:69]
    v_pk_mul_f32 v[246:247], v[78:79], s[68:69]
    v_exp_f32_e64 v240, v240 clamp
    v_exp_f32_e64 v242, v242 clamp
    v_exp_f32_e64 v244, v244 clamp
    v_exp_f32_e64 v246, v246 clamp
    v_exp_f32_e64 v241, v241 clamp
    v_exp_f32_e64 v243, v243 clamp
    v_exp_f32_e64 v245, v245 clamp
    v_exp_f32_e64 v247, v247 clamp
    v_max_f32 v72, 0, v72
    v_max_f32 v74, 0, v74
    v_max_f32 v76, 0, v76
    v_max_f32 v78, 0, v78
    v_max_f32 v73, 0, v73
    v_max_f32 v75, 0, v75
    v_max_f32 v77, 0, v77
    v_max_f32 v79, 0, v79
    v_pk_add_f32 v[72:73], v[72:73], s[70:71]
    v_pk_add_f32 v[74:75], v[74:75], s[70:71]
    v_pk_add_f32 v[76:77], v[76:77], s[70:71]
    v_pk_add_f32 v[78:79], v[78:79], s[70:71]
    v_pk_add_f32 v[240:241], v[240:241], v[72:73]
    v_pk_add_f32 v[242:243], v[242:243], v[74:75]
    v_pk_add_f32 v[244:245], v[244:245], v[76:77]
    v_pk_add_f32 v[246:247], v[246:247], v[78:79]
    v_cvt_pk_bf16_f32 v164, v240, v241
    v_cvt_pk_bf16_f32 v165, v242, v243
    v_cvt_pk_bf16_f32 v166, v244, v245
    v_cvt_pk_bf16_f32 v167, v246, v247
    v_pk_mul_f32 v[240:241], v[80:81], s[68:69]
    v_pk_mul_f32 v[242:243], v[82:83], s[68:69]
    v_pk_mul_f32 v[244:245], v[84:85], s[68:69]
    v_pk_mul_f32 v[246:247], v[86:87], s[68:69]
    v_exp_f32_e64 v240, v240 clamp
    v_exp_f32_e64 v242, v242 clamp
    v_exp_f32_e64 v244, v244 clamp
    v_exp_f32_e64 v246, v246 clamp
    v_exp_f32_e64 v241, v241 clamp
    v_exp_f32_e64 v243, v243 clamp
    v_exp_f32_e64 v245, v245 clamp
    v_exp_f32_e64 v247, v247 clamp
    v_max_f32 v80, 0, v80
    v_max_f32 v82, 0, v82
    v_max_f32 v84, 0, v84
    v_max_f32 v86, 0, v86
    v_max_f32 v81, 0, v81
    v_max_f32 v83, 0, v83
    v_max_f32 v85, 0, v85
    v_max_f32 v87, 0, v87
    v_pk_add_f32 v[80:81], v[80:81], s[70:71]
    v_pk_add_f32 v[82:83], v[82:83], s[70:71]
    v_pk_add_f32 v[84:85], v[84:85], s[70:71]
    v_pk_add_f32 v[86:87], v[86:87], s[70:71]
    v_pk_add_f32 v[240:241], v[240:241], v[80:81]
    v_pk_add_f32 v[242:243], v[242:243], v[82:83]
    v_pk_add_f32 v[244:245], v[244:245], v[84:85]
    v_pk_add_f32 v[246:247], v[246:247], v[86:87]
    v_cvt_pk_bf16_f32 v168, v240, v241
    v_cvt_pk_bf16_f32 v169, v242, v243
    v_cvt_pk_bf16_f32 v170, v244, v245
    v_cvt_pk_bf16_f32 v171, v246, v247
    v_pk_mul_f32 v[240:241], v[88:89], s[68:69]
    v_pk_mul_f32 v[242:243], v[90:91], s[68:69]
    v_pk_mul_f32 v[244:245], v[92:93], s[68:69]
    v_pk_mul_f32 v[246:247], v[94:95], s[68:69]
    v_exp_f32_e64 v240, v240 clamp
    v_exp_f32_e64 v242, v242 clamp
    v_exp_f32_e64 v244, v244 clamp
    v_exp_f32_e64 v246, v246 clamp
    v_exp_f32_e64 v241, v241 clamp
    v_exp_f32_e64 v243, v243 clamp
    v_exp_f32_e64 v245, v245 clamp
    v_exp_f32_e64 v247, v247 clamp
    v_max_f32 v88, 0, v88
    v_max_f32 v90, 0, v90
    v_max_f32 v92, 0, v92
    v_max_f32 v94, 0, v94
    v_max_f32 v89, 0, v89
    v_max_f32 v91, 0, v91
    v_max_f32 v93, 0, v93
    v_max_f32 v95, 0, v95
    v_pk_add_f32 v[88:89], v[88:89], s[70:71]
    v_pk_add_f32 v[90:91], v[90:91], s[70:71]
    v_pk_add_f32 v[92:93], v[92:93], s[70:71]
    v_pk_add_f32 v[94:95], v[94:95], s[70:71]
    v_pk_add_f32 v[240:241], v[240:241], v[88:89]
    v_pk_add_f32 v[242:243], v[242:243], v[90:91]
    v_pk_add_f32 v[244:245], v[244:245], v[92:93]
    v_pk_add_f32 v[246:247], v[246:247], v[94:95]
    v_cvt_pk_bf16_f32 v172, v240, v241
    v_cvt_pk_bf16_f32 v173, v242, v243
    v_cvt_pk_bf16_f32 v174, v244, v245
    v_cvt_pk_bf16_f32 v175, v246, v247
    s_waitcnt vmcnt(0) lgkmcnt(0)
    v_cvt_pk_bf16_f32 v63, v62, v63
    v_cvt_pk_bf16_f32 v62, v60, v61
    v_cvt_pk_bf16_f32 v61, v58, v59
    v_cvt_pk_bf16_f32 v60, v56, v57
    v_cvt_pk_bf16_f32 v59, v54, v55
    v_cvt_pk_bf16_f32 v58, v52, v53
    v_cvt_pk_bf16_f32 v57, v50, v51
    v_cvt_pk_bf16_f32 v56, v48, v49
    v_mov_b32_dpp v60, v60 row_newbcast:0 row_mask:0xf bank_mask:0xf
    v_mov_b32_dpp v61, v61 row_newbcast:0 row_mask:0xf bank_mask:0xf
    v_mov_b32_dpp v62, v62 row_newbcast:0 row_mask:0xf bank_mask:0xf
    v_mov_b32_dpp v63, v63 row_newbcast:0 row_mask:0xf bank_mask:0xf
    v_cndmask_b32 v48, v56, v60, s[64:65]
    v_cndmask_b32 v52, v60, v56, s[64:65]
    v_cndmask_b32 v49, v57, v61, s[64:65]
    v_cndmask_b32 v53, v61, v57, s[64:65]
    v_cndmask_b32 v50, v58, v62, s[64:65]
    v_cndmask_b32 v54, v62, v58, s[64:65]
    v_cndmask_b32 v51, v59, v63, s[64:65]
    v_cndmask_b32 v55, v63, v59, s[64:65]
    s_nop 1
    v_mfma_f32_32x32x16_bf16 v[96:111], v[48:51], v[160:163], 0
    v_mfma_f32_32x32x16_bf16 v[112:127], v[52:55], v[164:167], 0
    v_mfma_f32_32x32x16_bf16 v[128:143], v[48:51], v[168:171], 0
    v_mfma_f32_32x32x16_bf16 v[144:159], v[52:55], v[172:175], 0
    s_add_u32 m0, s36, 36864
    s_lshl3_add_u32 s53, s73, s43
    buffer_load_dwordx4 v10, s[16:19], s53 offen lds
    s_nop 8
    v_add_f32 v104, s70, v104
    v_add_f32 v112, s70, v112
    v_add_f32 v136, s70, v136
    v_add_f32 v144, s70, v144
    v_rcp_f32 v104, v104
    buffer_load_dwordx4 v11, s[16:19], s53 offen offset:1024 lds
    v_rcp_f32 v112, v112
    v_rcp_f32 v136, v136
    v_rcp_f32 v144, v144
    v_mul_f32 v104, v104, v28
    v_mul_f32 v112, v112, v28
    v_mul_f32 v136, v136, v29
    v_mul_f32 v144, v144, v29
    v_pk_mul_f32 v[96:97], v[96:97], v[104:105] op_sel_hi:[1,0]
    v_pk_mul_f32 v[98:99], v[98:99], v[104:105] op_sel_hi:[1,0]
    v_pk_mul_f32 v[100:101], v[100:101], v[104:105] op_sel_hi:[1,0]
    v_pk_mul_f32 v[102:103], v[102:103], v[104:105] op_sel_hi:[1,0]
    v_cvt_pk_bf16_f32 v176, v96, v97
    buffer_load_dwordx4 v2, s[16:19], s53 offen offset:2048 lds
    v_cvt_pk_bf16_f32 v177, v98, v99
    v_cvt_pk_bf16_f32 v178, v100, v101
    v_cvt_pk_bf16_f32 v179, v102, v103
    buffer_store_dwordx4 v[176:179], v27, s[20:23], s48 offen sc1
    v_pk_mul_f32 v[120:121], v[120:121], v[112:113] op_sel_hi:[1,0]
    v_pk_mul_f32 v[122:123], v[122:123], v[112:113] op_sel_hi:[1,0]
    v_pk_mul_f32 v[124:125], v[124:125], v[112:113] op_sel_hi:[1,0]
    v_pk_mul_f32 v[126:127], v[126:127], v[112:113] op_sel_hi:[1,0]
    v_cvt_pk_bf16_f32 v180, v120, v121
    v_cvt_pk_bf16_f32 v181, v122, v123
    v_cvt_pk_bf16_f32 v182, v124, v125
    v_cvt_pk_bf16_f32 v183, v126, v127
    buffer_store_dwordx4 v[180:183], v27, s[20:23], s48 offen offset:2048 sc1
    v_pk_mul_f32 v[128:129], v[128:129], v[136:137] op_sel_hi:[1,0]
    v_pk_mul_f32 v[130:131], v[130:131], v[136:137] op_sel_hi:[1,0]
    v_pk_mul_f32 v[132:133], v[132:133], v[136:137] op_sel_hi:[1,0]
    v_pk_mul_f32 v[134:135], v[134:135], v[136:137] op_sel_hi:[1,0]
    v_cvt_pk_bf16_f32 v184, v128, v129
    v_cvt_pk_bf16_f32 v185, v130, v131
    v_cvt_pk_bf16_f32 v186, v132, v133
    v_cvt_pk_bf16_f32 v187, v134, v135
    buffer_store_dwordx4 v[184:187], v27, s[20:23], s49 offen sc1
    v_pk_mul_f32 v[152:153], v[152:153], v[144:145] op_sel_hi:[1,0]
    v_pk_mul_f32 v[154:155], v[154:155], v[144:145] op_sel_hi:[1,0]
    v_pk_mul_f32 v[156:157], v[156:157], v[144:145] op_sel_hi:[1,0]
    v_pk_mul_f32 v[158:159], v[158:159], v[144:145] op_sel_hi:[1,0]
    v_cvt_pk_bf16_f32 v188, v152, v153
    v_cvt_pk_bf16_f32 v189, v154, v155
    v_cvt_pk_bf16_f32 v190, v156, v157
    v_cvt_pk_bf16_f32 v191, v158, v159
    buffer_store_dwordx4 v[188:191], v27, s[20:23], s49 offen offset:2048 sc1
    buffer_load_dwordx2 v[30:31], v32, s[20:23], 0 offen offset:32 sc1
    s_waitcnt vmcnt(0)
Qs_pc_1:
    s_add_u32 s54, s51, 1
    v_subrev_u32 v34, s54, v30
    v_cmp_eq_u32 s[66:67], s52, v31
    v_cmp_ge_u32 vcc, 2, v34
    s_nop 1
    s_and_b64 vcc, vcc, s[66:67]
    s_cmp_eq_u64 vcc, -1
    s_cbranch_scc1 Qs_pok_2
    s_add_u32 s63, s63, 1
    s_cmp_lt_u32 s63, 0x40000
    s_cbranch_scc0 L_end
    s_sleep 1
    buffer_load_dwordx2 v[30:31], v32, s[20:23], 0 offen offset:32 sc1
    s_waitcnt vmcnt(0)
    s_branch Qs_pc_1
Qs_pok_2:
    buffer_load_dwordx4 v[192:195], v27, s[20:23], s4 offen sc1
    buffer_load_dwordx4 v[196:199], v27, s[20:23], s4 offen offset:1024 sc1
    buffer_load_dwordx4 v[200:203], v27, s[20:23], s4 offen offset:2048 sc1
    buffer_load_dwordx4 v[204:207], v27, s[20:23], s4 offen offset:3072 sc1
    buffer_load_dwordx4 v[208:211], v27, s[20:23], s5 offen sc1
    buffer_load_dwordx4 v[212:215], v27, s[20:23], s5 offen offset:1024 sc1
    buffer_load_dwordx4 v[216:219], v27, s[20:23], s5 offen offset:2048 sc1
    buffer_load_dwordx4 v[220:223], v27, s[20:23], s5 offen offset:3072 sc1
    buffer_load_dwordx4 v[224:227], v27, s[20:23], s6 offen sc1
    buffer_load_dwordx4 v[228:231], v27, s[20:23], s6 offen offset:1024 sc1
    buffer_load_dwordx4 v[232:235], v27, s[20:23], s6 offen offset:2048 sc1
    buffer_load_dwordx4 v[236:239], v27, s[20:23], s6 offen offset:3072 sc1
    s_waitcnt vmcnt(0)
    s_branch Q_join_8
L_pathH:
    s_mov_b32 s68, 0xbfb8aa3b
    s_mov_b32 s69, s68
    s_mov_b32 s12, s90
    s_and_b32 s13, s91, 0xffff
    s_mov_b32 s14, 1409024
    s_mov_b32 s15, 0x00020000
    s_mov_b32 s16, s100
    s_and_b32 s17, s101, 0xffff
    s_mov_b32 s18, 524288
    s_mov_b32 s19, 0x00020000
    s_waitcnt vmcnt(8)
    s_barrier
    ds_read_b64_tr_b16 v[48:49], v21 offset:6144
    ds_read_b64_tr_b16 v[50:51], v21 offset:6656
    ds_read_b128 a[0:3], v12 offset:2048
    ds_read_b128 a[4:7], v16 offset:2048
    ds_read_b128 v[128:131], v20 offset:0
    ds_read_b64_tr_b16 v[52:53], v22 offset:6144
    ds_read_b64_tr_b16 v[54:55], v22 offset:6656
    ds_read_b128 a[8:11], v13 offset:2048
    ds_read_b128 a[12:15], v17 offset:2048
    ds_read_b128 v[132:135], v20 offset:32
    s_waitcnt lgkmcnt(5)
    ds_read_b64_tr_b16 v[56:57], v23 offset:6144
    ds_read_b64_tr_b16 v[58:59], v23 offset:6656
    v_mfma_f32_32x32x16_bf16 v[64:79], v[48:51], a[0:3], 0
    s_add_u32 m0, s36, 14336
    s_add_u32 s53, s37, 256
    buffer_load_dwordx4 v2, s[4:7], s53 offen lds
    s_mov_b32 s20, s98
    ds_read_b128 a[16:19], v14 offset:2048
    ds_read_b128 a[20:23], v18 offset:2048
    v_mfma_f32_32x32x16_bf16 v[80:95], v[48:51], a[4:7], 0
    buffer_load_dwordx4 v3, s[4:7], s53 offen offset:1024 lds
    s_and_b32 s21, s99, 0xffff
    ds_read_b128 v[136:139], v20 offset:64
    v_mfma_f32_16x16x32_bf16 v[44:47], v[128:131], a[0:3], 0
    s_mov_b32 s22, 9437184
    s_waitcnt lgkmcnt(5)
    ds_read_b64_tr_b16 v[60:61], v24 offset:6144
    ds_read_b64_tr_b16 v[62:63], v24 offset:6656
    v_mfma_f32_32x32x16_bf16 v[64:79], v[52:55], a[8:11], v[64:79]
    buffer_load_dwordx4 v4, s[4:7], s53 offen offset:2048 lds
    s_mov_b32 s23, 0x00020000
    ds_read_b128 a[24:27], v15 offset:2048
    ds_read_b128 a[28:31], v19 offset:2048
    v_mfma_f32_32x32x16_bf16 v[80:95], v[52:55], a[12:15], v[80:95]
    buffer_load_dwordx4 v5, s[4:7], s53 offen offset:3072 lds
    s_mul_i32 s62, s58, 4352
    ds_read_b128 v[140:143], v20 offset:96
    v_mfma_f32_16x16x32_bf16 v[44:47], v[132:135], a[8:11], v[44:47]
    s_add_u32 s62, s62, 7864320
    s_waitcnt lgkmcnt(5)
    s_waitcnt vmcnt(6)
    s_barrier
    ds_read_b64_tr_b16 v[48:49], v21 offset:12288
    ds_read_b64_tr_b16 v[50:51], v21 offset:12800
    v_mfma_f32_32x32x16_bf16 v[64:79], v[56:59], a[16:19], v[64:79]
    s_add_u32 m0, s36, 18432
    s_add_u32 s53, s38, 352256
    buffer_load_dwordx4 v6, s[8:11], s53 offen lds
    s_lshl_b32 s33, s58, 9
    ds_read_b128 a[32:35], v12 offset:8192
    ds_read_b128 a[36:39], v16 offset:8192
    v_mfma_f32_32x32x16_bf16 v[80:95], v[56:59], a[20:23], v[80:95]
    buffer_load_dwordx4 v7, s[8:11], s53 offen offset:1024 lds
    s_add_u32 s33, s33, 7962624
    ds_read_b128 v[128:131], v20 offset:128
    v_mfma_f32_16x16x32_bf16 v[44:47], v[136:139], a[16:19], v[44:47]
    s_mov_b32 s63, 0
    s_waitcnt lgkmcnt(5)
    ds_read_b64_tr_b16 v[52:53], v22 offset:12288
    ds_read_b64_tr_b16 v[54:55], v22 offset:12800
    v_mfma_f32_32x32x16_bf16 v[64:79], v[60:63], a[24:27], v[64:79]
    s_add_u32 m0, s36, 20480
    s_add_u32 s53, s37, 384
    buffer_load_dwordx4 v2, s[4:7], s53 offen lds
    ds_read_b128 a[40:43], v13 offset:8192
    ds_read_b128 a[44:47], v17 offset:8192
    v_mfma_f32_32x32x16_bf16 v[80:95], v[60:63], a[28:31], v[80:95]
    buffer_load_dwordx4 v3, s[4:7], s53 offen offset:1024 lds
    s_and_b32 s76, s2, 7
    ds_read_b128 v[132:135], v20 offset:160
    v_mfma_f32_16x16x32_bf16 v[44:47], v[140:143], a[24:27], v[44:47]
    s_lshr_b32 s77, s2, 3
    s_waitcnt lgkmcnt(5)
    ds_read_b64_tr_b16 v[56:57], v23 offset:12288
    ds_read_b64_tr_b16 v[58:59], v23 offset:12800
    v_mfma_f32_32x32x16_bf16 v[64:79], v[48:51], a[32:35], v[64:79]
    buffer_load_dwordx4 v4, s[4:7], s53 offen offset:2048 lds
    s_lshr_b32 s79, s76, 2
    ds_read_b128 a[48:51], v14 offset:8192
    ds_read_b128 a[52:55], v18 offset:8192
    v_mfma_f32_32x32x16_bf16 v[80:95], v[48:51], a[36:39], v[80:95]
    buffer_load_dwordx4 v5, s[4:7], s53 offen offset:3072 lds
    s_add_u32 s78, s76, s79
    ds_read_b128 v[136:139], v20 offset:192
    v_mfma_f32_16x16x32_bf16 v[44:47], v[128:131], a[32:35], v[44:47]
    s_add_u32 s78, s78, 1
    s_waitcnt lgkmcnt(5)
    ds_read_b64_tr_b16 v[60:61], v24 offset:12288
    ds_read_b64_tr_b16 v[62:63], v24 offset:12800
    v_mfma_f32_32x32x16_bf16 v[64:79], v[52:55], a[40:43], v[64:79]
    s_add_u32 m0, s36, 24576
    s_add_u32 s53, s38, 528384
    buffer_load_dwordx4 v6, s[8:11], s53 offen lds
    s_and_b32 s78, s78, 3
    ds_read_b128 a[56:59], v15 offset:8192
    ds_read_b128 a[60:63], v19 offset:8192
    v_mfma_f32_32x32x16_bf16 v[80:95], v[52:55], a[44:47], v[80:95]
    buffer_load_dwordx4 v7, s[8:11], s53 offen offset:1024 lds
    s_xor_b32 s79, s79, 1
    ds_read_b128 v[140:143], v20 offset:224
    v_mfma_f32_16x16x32_bf16 v[44:47], v[132:135], a[40:43], v[44:47]
    s_xor_b32 s60, s61, 1
    s_waitcnt lgkmcnt(5)
    s_waitcnt vmcnt(6)
    s_barrier
    ds_read_b64_tr_b16 v[48:49], v21 offset:18432
    ds_read_b64_tr_b16 v[50:51], v21 offset:18944
    v_mfma_f32_32x32x16_bf16 v[64:79], v[56:59], a[48:51], v[64:79]
    s_add_u32 m0, s36, 2048
    s_add_u32 s53, s37, 512
    buffer_load_dwordx4 v2, s[4:7], s53 offen lds
    s_lshl1_add_u32 s60, s79, s60
    ds_read_b128 a[64:67], v12 offset:14336
    ds_read_b128 a[68:71], v16 offset:14336
    v_mfma_f32_32x32x16_bf16 v[80:95], v[56:59], a[52:55], v[80:95]
    buffer_load_dwordx4 v3, s[4:7], s53 offen offset:1024 lds
    s_bfe_u32 s79, s77, 0x10003
    ds_read_b128 v[128:131], v20 offset:256
    v_mfma_f32_16x16x32_bf16 v[44:47], v[136:139], a[48:51], v[44:47]
    s_lshl1_add_u32 s60, s60, s79
    s_waitcnt lgkmcnt(5)
    ds_read_b64_tr_b16 v[52:53], v22 offset:18432
    ds_read_b64_tr_b16 v[54:55], v22 offset:18944
    v_mfma_f32_32x32x16_bf16 v[64:79], v[60:63], a[56:59], v[64:79]
    buffer_load_dwordx4 v4, s[4:7], s53 offen offset:2048 lds
    s_lshr_b32 s79, s77, 4
    ds_read_b128 a[72:75], v13 offset:14336
    ds_read_b128 a[76:79], v17 offset:14336
    v_mfma_f32_32x32x16_bf16 v[80:95], v[60:63], a[60:63], v[80:95]
    buffer_load_dwordx4 v5, s[4:7], s53 offen offset:3072 lds
    s_lshl1_add_u32 s78, s78, s79
    ds_read_b128 v[132:135], v20 offset:288
    v_mfma_f32_16x16x32_bf16 v[44:47], v[140:143], a[56:59], v[44:47]
    s_and_b32 s77, s77, 3
    s_waitcnt lgkmcnt(5)
    ds_read_b64_tr_b16 v[56:57], v23 offset:18432
    ds_read_b64_tr_b16 v[58:59], v23 offset:18944
    v_mfma_f32_32x32x16_bf16 v[64:79], v[48:51], a[64:67], v[64:79]
    s_add_u32 m0, s36, 6144
    s_add_u32 s53, s38, 704512
    buffer_load_dwordx4 v6, s[8:11], s53 offen lds
    s_lshl2_add_u32 s59, s78, s77
    ds_read_b128 a[80:83], v14 offset:14336
    ds_read_b128 a[84:87], v18 offset:14336
    v_mfma_f32_32x32x16_bf16 v[80:95], v[48:51], a[68:71], v[80:95]
    buffer_load_dwordx4 v7, s[8:11], s53 offen offset:1024 lds
    s_mov_b32 s24, s94
    ds_read_b128 v[136:139], v20 offset:320
    v_mfma_f32_16x16x32_bf16 v[44:47], v[128:131], a[64:67], v[44:47]
    s_and_b32 s25, s95, 0xffff
    s_waitcnt lgkmcnt(5)
    ds_read_b64_tr_b16 v[60:61], v24 offset:18432
    ds_read_b64_tr_b16 v[62:63], v24 offset:18944
    v_mfma_f32_32x32x16_bf16 v[64:79], v[52:55], a[72:75], v[64:79]
    s_add_u32 m0, s36, 26624
    s_add_u32 s53, s37, 640
    buffer_load_dwordx4 v2, s[4:7], s53 offen lds
    s_mov_b32 s26, 2097152
    ds_read_b128 a[88:91], v15 offset:14336
    ds_read_b128 a[92:95], v19 offset:14336
    v_mfma_f32_32x32x16_bf16 v[80:95], v[52:55], a[76:79], v[80:95]
    buffer_load_dwordx4 v3, s[4:7], s53 offen offset:1024 lds
    s_mov_b32 s27, 0x00020000
    ds_read_b128 v[140:143], v20 offset:352
    v_mfma_f32_16x16x32_bf16 v[44:47], v[132:135], a[72:75], v[44:47]
    v_add_u32 v11, 7168, v10
    s_waitcnt lgkmcnt(5)
    s_waitcnt vmcnt(8)
    s_barrier
    ds_read_b64_tr_b16 v[48:49], v21 offset:24576
    ds_read_b64_tr_b16 v[50:51], v21 offset:25088
    v_mfma_f32_32x32x16_bf16 v[64:79], v[56:59], a[80:83], v[64:79]
    buffer_load_dwordx4 v4, s[4:7], s53 offen offset:2048 lds
    v_xor_b32 v26, 64, v25
    ds_read_b128 a[96:99], v12 offset:20480
    ds_read_b128 a[100:103], v16 offset:20480
    v_mfma_f32_32x32x16_bf16 v[80:95], v[56:59], a[84:87], v[80:95]
    buffer_load_dwordx4 v5, s[4:7], s53 offen offset:3072 lds
    v_add_u32 v25, s36, v25
    ds_read_b128 v[128:131], v20 offset:384
    v_mfma_f32_16x16x32_bf16 v[44:47], v[136:139], a[80:83], v[44:47]
    v_add_u32 v26, s36, v26
    s_waitcnt lgkmcnt(5)
    ds_read_b64_tr_b16 v[52:53], v22 offset:24576
    ds_read_b64_tr_b16 v[54:55], v22 offset:25088
    v_mfma_f32_32x32x16_bf16 v[64:79], v[60:63], a[88:91], v[64:79]
    s_add_u32 m0, s36, 8192
    s_add_u32 s53, s38, 880640
    buffer_load_dwordx4 v6, s[8:11], s53 offen lds
    v_lshrrev_b32 v33, 2, v27
    ds_read_b128 a[104:107], v13 offset:20480
    ds_read_b128 a[108:111], v17 offset:20480
    v_mfma_f32_32x32x16_bf16 v[80:95], v[60:63], a[92:95], v[80:95]
    buffer_load_dwordx4 v7, s[8:11], s53 offen offset:1024 lds
    v_and_b32 v32, 3, v1
    ds_read_b128 v[132:135], v20 offset:416
    v_mfma_f32_16x16x32_bf16 v[44:47], v[140:143], a[88:91], v[44:47]
    v_lshlrev_b32 v32, 3, v32
    v_mov_b32 v30, 0
    buffer_load_dwordx2 v[30:31], v30, s[28:31], 0 offen sc1
    s_waitcnt lgkmcnt(5)
    ds_read_b64_tr_b16 v[56:57], v23 offset:24576
    ds_read_b64_tr_b16 v[58:59], v23 offset:25088
    v_mfma_f32_32x32x16_bf16 v[64:79], v[48:51], a[96:99], v[64:79]
    s_add_u32 m0, s36, 10240
    s_add_u32 s53, s37, 768
    buffer_load_dwordx4 v2, s[4:7], s53 offen lds
    s_lshl2_add_u32 s76, s59, s3
    ds_read_b128 a[112:115], v14 offset:20480
    ds_read_b128 a[116:119], v18 offset:20480
    v_mfma_f32_32x32x16_bf16 v[80:95], v[48:51], a[100:103], v[80:95]
    buffer_load_dwordx4 v3, s[4:7], s53 offen offset:1024 lds
    s_lshl_b32 s32, s76, 14
    ds_read_b128 v[136:139], v20 offset:448
    v_mfma_f32_16x16x32_bf16 v[44:47], v[128:131], a[96:99], v[44:47]
    s_lshl_b32 s76, s76, 7
    s_waitcnt lgkmcnt(5)
    ds_read_b64_tr_b16 v[60:61], v24 offset:24576
    ds_read_b64_tr_b16 v[62:63], v24 offset:25088
    v_mfma_f32_32x32x16_bf16 v[64:79], v[52:55], a[104:107], v[64:79]
    buffer_load_dwordx4 v4, s[4:7], s53 offen offset:2048 lds
    s_add_u32 s76, s76, 7929856
    ds_read_b128 a[120:123], v15 offset:20480
    ds_read_b128 a[124:127], v19 offset:20480
    v_mfma_f32_32x32x16_bf16 v[80:95], v[52:55], a[108:111], v[80:95]
    buffer_load_dwordx4 v5, s[4:7], s53 offen offset:3072 lds
    v_add_u32 v32, s76, v32
    ds_read_b128 v[140:143], v20 offset:480
    v_mfma_f32_16x16x32_bf16 v[44:47], v[132:135], a[104:107], v[44:47]
    s_lshl_b32 s78, s60, 7
    s_waitcnt lgkmcnt(5)
    s_waitcnt vmcnt(11)
    s_barrier
    ds_read_b64_tr_b16 v[48:49], v21 offset:6144
    ds_read_b64_tr_b16 v[50:51], v21 offset:6656
    v_mfma_f32_32x32x16_bf16 v[64:79], v[56:59], a[112:115], v[64:79]
    s_add_u32 m0, s36, 14336
    s_add_u32 s53, s38, 1056768
    buffer_load_dwordx4 v6, s[8:11], s53 offen lds
    s_add_u32 s32, s32, s78
    ds_read_b128 a[128:131], v12 offset:2048
    ds_read_b128 a[132:135], v16 offset:2048
    v_mfma_f32_32x32x16_bf16 v[80:95], v[56:59], a[116:119], v[80:95]
    buffer_load_dwordx4 v7, s[8:11], s53 offen offset:1024 lds
    s_mov_b32 s64, 0xffff0000
    ds_read_b128 v[128:131], v20 offset:512
    v_mfma_f32_16x16x32_bf16 v[44:47], v[136:139], a[112:115], v[44:47]
    s_mov_b32 s65, 0xffff0000
    s_waitcnt lgkmcnt(5)
    ds_read_b64_tr_b16 v[52:53], v22 offset:6144
    ds_read_b64_tr_b16 v[54:55], v22 offset:6656
    v_mfma_f32_32x32x16_bf16 v[64:79], v[60:63], a[120:123], v[64:79]
    s_add_u32 m0, s36, 16384
    s_add_u32 s53, s37, 896
    buffer_load_dwordx4 v2, s[4:7], s53 offen lds
    s_mul_i32 s76, s3, 11
    ds_read_b128 a[136:139], v13 offset:2048
    ds_read_b128 a[140:143], v17 offset:2048
    v_mfma_f32_32x32x16_bf16 v[80:95], v[60:63], a[124:127], v[80:95]
    buffer_load_dwordx4 v3, s[4:7], s53 offen offset:1024 lds
    s_add_u32 s77, s76, 6
    ds_read_b128 v[132:135], v20 offset:544
    v_mfma_f32_16x16x32_bf16 v[44:47], v[140:143], a[120:123], v[44:47]
    s_min_u32 s77, s77, 38
    s_waitcnt lgkmcnt(5)
    ds_read_b64_tr_b16 v[56:57], v23 offset:6144
    ds_read_b64_tr_b16 v[58:59], v23 offset:6656
    v_mfma_f32_32x32x16_bf16 v[64:79], v[48:51], a[128:131], v[64:79]
    buffer_load_dwordx4 v4, s[4:7], s53 offen offset:2048 lds
    s_lshl_b32 s40, s76, 15
    ds_read_b128 a[144:147], v14 offset:2048
    ds_read_b128 a[148:151], v18 offset:2048
    v_mfma_f32_32x32x16_bf16 v[80:95], v[48:51], a[132:135], v[80:95]
    buffer_load_dwordx4 v5, s[4:7], s53 offen offset:3072 lds
    s_add_u32 s40, s40, s78
    ds_read_b128 v[136:139], v20 offset:576
    v_mfma_f32_16x16x32_bf16 v[44:47], v[128:131], a[128:131], v[44:47]
    s_lshl_b32 s41, s77, 15
    s_waitcnt lgkmcnt(5)
    ds_read_b64_tr_b16 v[60:61], v24 offset:6144
    ds_read_b64_tr_b16 v[62:63], v24 offset:6656
    v_mfma_f32_32x32x16_bf16 v[64:79], v[52:55], a[136:139], v[64:79]
    s_add_u32 m0, s36, 30720
    s_add_u32 s53, s38, 1232896
    buffer_load_dwordx4 v6, s[8:11], s53 offen lds
    s_add_u32 s41, s41, s78
    ds_read_b128 a[152:155], v15 offset:2048
    ds_read_b128 a[156:159], v19 offset:2048
    v_mfma_f32_32x32x16_bf16 v[80:95], v[52:55], a[140:143], v[80:95]
    buffer_load_dwordx4 v7, s[8:11], s53 offen offset:1024 lds
    s_lshl_b32 s43, s3, 17
    ds_read_b128 v[140:143], v20 offset:608
    v_mfma_f32_16x16x32_bf16 v[44:47], v[132:135], a[136:139], v[44:47]
    s_add_u32 s43, s43, s78
    s_waitcnt lgkmcnt(5)
    s_waitcnt vmcnt(13)
    s_barrier
    ds_read_b64_tr_b16 v[48:49], v21 offset:8192
    ds_read_b64_tr_b16 v[50:51], v21 offset:8704
    v_mfma_f32_32x32x16_bf16 v[64:79], v[56:59], a[144:147], v[64:79]
    s_add_u32 m0, s36, 20480
    s_add_u32 s53, s38, 128
    buffer_load_dwordx4 v6, s[8:11], s53 offen lds
    s_mul_i32 s78, s59, 241664
    ds_read_b128 a[160:163], v12 offset:26624
    ds_read_b128 a[164:167], v16 offset:26624
    v_mfma_f32_32x32x16_bf16 v[80:95], v[56:59], a[148:151], v[80:95]
    buffer_load_dwordx4 v7, s[8:11], s53 offen offset:1024 lds
    s_lshl_b32 s44, s76, 12
    ds_read_b128 v[128:131], v20 offset:640
    v_mfma_f32_16x16x32_bf16 v[44:47], v[136:139], a[144:147], v[44:47]
    s_add_u32 s44, s44, s78
    s_waitcnt lgkmcnt(5)
    ds_read_b64_tr_b16 v[52:53], v22 offset:8192
    ds_read_b64_tr_b16 v[54:55], v22 offset:8704
    v_mfma_f32_32x32x16_bf16 v[64:79], v[60:63], a[152:155], v[64:79]
    s_add_u32 m0, s36, 22528
    s_add_u32 s53, s38, 176256
    buffer_load_dwordx4 v6, s[8:11], s53 offen lds
    s_lshl_b32 s45, s77, 12
    ds_read_b128 a[168:171], v13 offset:26624
    ds_read_b128 a[172:175], v17 offset:26624
    v_mfma_f32_32x32x16_bf16 v[80:95], v[60:63], a[156:159], v[80:95]
    buffer_load_dwordx4 v7, s[8:11], s53 offen offset:1024 lds
    s_add_u32 s45, s45, s78
    ds_read_b128 v[132:135], v20 offset:672
    v_mfma_f32_16x16x32_bf16 v[44:47], v[140:143], a[152:155], v[44:47]
    s_lshl_b32 s47, s3, 14
    s_lshl2_add_u32 s54, s59, s3
    s_mul_i32 s54, s54, 15360
    s_lshl_b32 s55, s60, 7
    s_add_u32 s54, s54, s55
    v_lshlrev_b32 v253, 10, v1
    v_add_u32 v253, s54, v253
    v_subrev_u32 v251, 1409024, v253
    s_mov_b64 exec, 0x7fff
    buffer_load_dword v252, v253, s[12:15], 0 offen
    buffer_load_dword v252, v251, s[16:19], 0 offen
    s_mov_b64 exec, -1
    s_waitcnt lgkmcnt(5)
    ds_read_b64_tr_b16 v[56:57], v23 offset:8192
    ds_read_b64_tr_b16 v[58:59], v23 offset:8704
    v_mfma_f32_32x32x16_bf16 v[64:79], v[48:51], a[160:163], v[64:79]
    s_add_u32 m0, s36, 24576
    s_add_u32 s53, s38, 352384
    buffer_load_dwordx4 v6, s[8:11], s53 offen lds
    s_add_u32 s47, s47, s78
    ds_read_b128 a[176:179], v14 offset:26624
    ds_read_b128 a[180:183], v18 offset:26624
    v_mfma_f32_32x32x16_bf16 v[80:95], v[48:51], a[164:167], v[80:95]
    buffer_load_dwordx4 v7, s[8:11], s53 offen offset:1024 lds
    s_add_u32 s47, s47, 176128
    ds_read_b128 v[136:139], v20 offset:704
    v_mfma_f32_16x16x32_bf16 v[44:47], v[128:131], a[160:163], v[44:47]
    s_add_u32 s42, s40, 163840
    s_waitcnt lgkmcnt(5)
    ds_read_b64_tr_b16 v[60:61], v24 offset:8192
    ds_read_b64_tr_b16 v[62:63], v24 offset:8704
    v_mfma_f32_32x32x16_bf16 v[64:79], v[52:55], a[168:171], v[64:79]
    s_add_u32 s46, s44, 20480
    ds_read_b128 a[184:187], v15 offset:26624
    ds_read_b128 a[188:191], v19 offset:26624
    v_mfma_f32_32x32x16_bf16 v[80:95], v[52:55], a[172:175], v[80:95]
    s_cmp_eq_u32 s3, 3
    s_cselect_b32 s42, 1073741824, s42
    s_cselect_b32 s46, 1073741824, s46
    ds_read_b128 v[140:143], v20 offset:736
    v_mfma_f32_16x16x32_bf16 v[44:47], v[132:135], a[168:171], v[44:47]
    s_lshr_b32 s76, s3, 1
    s_waitcnt lgkmcnt(5)
    s_waitcnt vmcnt(14)
    s_barrier
    ds_read_b64_tr_b16 v[48:49], v21 offset:14336
    ds_read_b64_tr_b16 v[50:51], v21 offset:14848
    v_mfma_f32_32x32x16_bf16 v[64:79], v[56:59], a[176:179], v[64:79]
    s_lshl1_add_u32 s76, s57, s76
    ds_read_b128 a[192:195], v12 offset:10240
    ds_read_b128 a[196:199], v16 offset:10240
    v_mfma_f32_32x32x16_bf16 v[80:95], v[56:59], a[180:183], v[80:95]
    s_mul_i32 s48, s76, 241664
    ds_read_b128 v[128:131], v20 offset:768
    v_mfma_f32_16x16x32_bf16 v[44:47], v[136:139], a[176:179], v[44:47]
    s_lshl_b32 s78, s73, 12
    s_waitcnt lgkmcnt(5)
    ds_read_b64_tr_b16 v[52:53], v22 offset:14336
    ds_read_b64_tr_b16 v[54:55], v22 offset:14848
    v_mfma_f32_32x32x16_bf16 v[64:79], v[60:63], a[184:187], v[64:79]
    s_add_u32 s48, s48, s78
    ds_read_b128 a[200:203], v13 offset:10240
    ds_read_b128 a[204:207], v17 offset:10240
    v_mfma_f32_32x32x16_bf16 v[80:95], v[60:63], a[188:191], v[80:95]
    s_lshl_b32 s78, s75, 12
    ds_read_b128 v[132:135], v20 offset:800
    v_mfma_f32_16x16x32_bf16 v[44:47], v[140:143], a[184:187], v[44:47]
    s_add_u32 s48, s48, s78
H_nc_1:
    v_readfirstlane_b32 s51, v30
    v_readfirstlane_b32 s52, v31
    s_nop 1
    s_cmp_lg_u32 s52, 0
    s_cbranch_scc1 H_nok_2
    s_add_u32 s63, s63, 1
    s_cmp_lt_u32 s63, 0x40000
    s_cbranch_scc0 L_end
    s_sleep 1
    v_mov_b32 v30, 0
    buffer_load_dwordx2 v[30:31], v30, s[28:31], 0 offen sc1
    s_waitcnt vmcnt(0)
    s_branch H_nc_1
H_nok_2:
    s_waitcnt lgkmcnt(5)
    ds_read_b64_tr_b16 v[56:57], v23 offset:14336
    ds_read_b64_tr_b16 v[58:59], v23 offset:14848
    v_mfma_f32_32x32x16_bf16 v[64:79], v[48:51], a[192:195], v[64:79]
    s_add_u32 m0, s36, 2048
    s_add_u32 s53, s38, 528512
    buffer_load_dwordx4 v6, s[8:11], s53 offen lds
    s_lshl_b32 s78, s75, 10
    ds_read_b128 a[208:211], v14 offset:10240
    ds_read_b128 a[212:215], v18 offset:10240
    v_mfma_f32_32x32x16_bf16 v[80:95], v[48:51], a[196:199], v[80:95]
    buffer_load_dwordx4 v7, s[8:11], s53 offen offset:1024 lds
    s_xor_b32 s79, s78, 1024
    ds_read_b128 v[136:139], v20 offset:832
    v_mfma_f32_16x16x32_bf16 v[44:47], v[128:131], a[192:195], v[44:47]
    s_add_u32 s49, s48, s79
    s_add_u32 s48, s48, s78
    s_and_b32 s78, s74, s75
    s_mul_i32 s35, s78, 1073741824
    s_add_u32 s35, s35, 16384
    s_lshr_b32 s78, s58, 1
    s_lshl2_add_u32 s76, s76, s78
    s_lshl_b32 s76, s76, 7
    s_and_b32 s78, s58, 1
    s_lshl1_add_u32 s78, s61, s78
    s_lshl1_add_u32 s78, s78, s75
    s_lshl3_add_u32 s76, s78, s76
    s_add_u32 s50, s76, 7929856
    s_add_u32 s54, s60, s59
    s_add_u32 s55, s54, 0
    s_and_b32 s55, s55, 3
    s_lshl_b32 s73, s55, 12
    s_bitcmp1_b32 s55, 1
    s_cselect_b32 s28, s41, s40
    s_cselect_b32 s4, s45, s44
    s_and_b32 s55, s73, 4096
    s_add_u32 s4, s4, s55
    s_lshl3_add_u32 s28, s55, s28
    s_add_u32 s55, s54, 1
    s_and_b32 s55, s55, 3
    s_lshl_b32 s74, s55, 12
    s_bitcmp1_b32 s55, 1
    s_cselect_b32 s29, s41, s40
    s_cselect_b32 s5, s45, s44
    s_and_b32 s55, s74, 4096
    s_add_u32 s5, s5, s55
    s_lshl3_add_u32 s29, s55, s29
    s_add_u32 s55, s54, 2
    s_and_b32 s55, s55, 3
    s_lshl_b32 s78, s55, 12
    s_bitcmp1_b32 s55, 1
    s_cselect_b32 s30, s41, s40
    s_cselect_b32 s6, s45, s44
    s_and_b32 s55, s78, 4096
    s_add_u32 s6, s6, s55
    s_lshl3_add_u32 s30, s55, s30
    s_add_u32 s55, s54, 3
    s_and_b32 s55, s55, 3
    s_lshl_b32 s61, s55, 12
    s_bitcmp1_b32 s55, 1
    s_cselect_b32 s31, s41, s40
    s_cselect_b32 s7, s45, s44
    s_and_b32 s55, s61, 4096
    s_add_u32 s7, s7, s55
    s_lshl3_add_u32 s31, s55, s31
    v_add_u32 v2, 14336, v10
    v_add_u32 v3, 21504, v10
    s_waitcnt lgkmcnt(5)
    ds_read_b64_tr_b16 v[60:61], v24 offset:14336
    ds_read_b64_tr_b16 v[62:63], v24 offset:14848
    v_mfma_f32_32x32x16_bf16 v[64:79], v[52:55], a[200:203], v[64:79]
    ds_read_b128 a[216:219], v15 offset:10240
    ds_read_b128 a[220:223], v19 offset:10240
    v_mfma_f32_32x32x16_bf16 v[80:95], v[52:55], a[204:207], v[80:95]
    ds_read_b128 v[140:143], v20 offset:864
    v_mfma_f32_16x16x32_bf16 v[44:47], v[132:135], a[200:203], v[44:47]
    s_waitcnt lgkmcnt(5)
    s_waitcnt vmcnt(10)
    s_barrier
    ds_read_b64_tr_b16 v[48:49], v21 offset:30720
    ds_read_b64_tr_b16 v[50:51], v21 offset:31232
    v_mfma_f32_32x32x16_bf16 v[64:79], v[56:59], a[208:211], v[64:79]
    ds_read_b128 a[224:227], v12 offset:16384
    ds_read_b128 a[228:231], v16 offset:16384
    v_mfma_f32_32x32x16_bf16 v[80:95], v[56:59], a[212:215], v[80:95]
    ds_read_b128 v[128:131], v20 offset:896
    v_mfma_f32_16x16x32_bf16 v[44:47], v[136:139], a[208:211], v[44:47]
    s_waitcnt lgkmcnt(5)
    ds_read_b64_tr_b16 v[52:53], v22 offset:30720
    ds_read_b64_tr_b16 v[54:55], v22 offset:31232
    v_mfma_f32_32x32x16_bf16 v[64:79], v[60:63], a[216:219], v[64:79]
    ds_read_b128 a[232:235], v13 offset:16384
    ds_read_b128 a[236:239], v17 offset:16384
    v_mfma_f32_32x32x16_bf16 v[80:95], v[60:63], a[220:223], v[80:95]
    ds_read_b128 v[132:135], v20 offset:928
    v_mfma_f32_16x16x32_bf16 v[44:47], v[140:143], a[216:219], v[44:47]
    s_waitcnt lgkmcnt(5)
    ds_read_b64_tr_b16 v[56:57], v23 offset:30720
    ds_read_b64_tr_b16 v[58:59], v23 offset:31232
    v_mfma_f32_32x32x16_bf16 v[64:79], v[48:51], a[224:227], v[64:79]
    s_add_u32 m0, s36, 4096
    s_add_u32 s53, s38, 704640
    buffer_load_dwordx4 v6, s[8:11], s53 offen lds
    ds_read_b128 a[240:243], v14 offset:16384
    ds_read_b128 a[244:247], v18 offset:16384
    v_mfma_f32_32x32x16_bf16 v[80:95], v[48:51], a[228:231], v[80:95]
    buffer_load_dwordx4 v7, s[8:11], s53 offen offset:1024 lds
    ds_read_b128 v[136:139], v20 offset:960
    v_mfma_f32_16x16x32_bf16 v[44:47], v[128:131], a[224:227], v[44:47]
    s_waitcnt lgkmcnt(5)
    ds_read_b64_tr_b16 v[60:61], v24 offset:30720
    ds_read_b64_tr_b16 v[62:63], v24 offset:31232
    v_mfma_f32_32x32x16_bf16 v[64:79], v[52:55], a[232:235], v[64:79]
    s_add_u32 m0, s36, 36864
    s_nop 0
    buffer_load_dwordx4 v10, s[12:15], s28 offen lds
    ds_read_b128 a[248:251], v15 offset:16384
    ds_read_b128 a[252:255], v19 offset:16384
    v_mfma_f32_32x32x16_bf16 v[80:95], v[52:55], a[236:239], v[80:95]
    buffer_load_dwordx4 v11, s[12:15], s28 offen offset:1024 lds
    ds_read_b128 v[140:143], v20 offset:992
    v_mfma_f32_16x16x32_bf16 v[44:47], v[132:135], a[232:235], v[44:47]
    s_waitcnt lgkmcnt(5)
    s_waitcnt vmcnt(10)
    s_barrier
    ds_read_b64_tr_b16 v[48:49], v21 offset:20480
    ds_read_b64_tr_b16 v[50:51], v21 offset:20992
    v_mfma_f32_32x32x16_bf16 v[64:79], v[56:59], a[240:243], v[64:79]
    buffer_load_dwordx4 v2, s[12:15], s28 offen offset:2048 lds
    v_mfma_f32_32x32x16_bf16 v[80:95], v[56:59], a[244:247], v[80:95]
    buffer_load_dwordx4 v3, s[12:15], s28 offen offset:3072 lds
    v_mfma_f32_16x16x32_bf16 v[44:47], v[136:139], a[240:243], v[44:47]
    s_waitcnt lgkmcnt(2)
    ds_read_b64_tr_b16 v[52:53], v22 offset:20480
    ds_read_b64_tr_b16 v[54:55], v22 offset:20992
    v_mfma_f32_32x32x16_bf16 v[64:79], v[60:63], a[248:251], v[64:79]
    s_add_u32 m0, s36, 32768
    s_nop 0
    buffer_load_dwordx4 v10, s[12:15], s29 offen lds
    v_mfma_f32_32x32x16_bf16 v[80:95], v[60:63], a[252:255], v[80:95]
    buffer_load_dwordx4 v11, s[12:15], s29 offen offset:1024 lds
    v_mfma_f32_16x16x32_bf16 v[44:47], v[140:143], a[248:251], v[44:47]
    s_waitcnt lgkmcnt(2)
    ds_read_b64_tr_b16 v[56:57], v23 offset:20480
    ds_read_b64_tr_b16 v[58:59], v23 offset:20992
    v_mfma_f32_32x32x16_bf16 v[96:111], v[48:51], a[0:3], 0
    v_mfma_f32_32x32x16_bf16 v[112:127], v[48:51], a[4:7], 0
    s_waitcnt lgkmcnt(2)
    ds_read_b64_tr_b16 v[60:61], v24 offset:20480
    ds_read_b64_tr_b16 v[62:63], v24 offset:20992
    v_mfma_f32_32x32x16_bf16 v[96:111], v[52:55], a[8:11], v[96:111]
    buffer_load_dwordx4 v2, s[12:15], s29 offen offset:2048 lds
    v_mfma_f32_32x32x16_bf16 v[112:127], v[52:55], a[12:15], v[112:127]
    s_waitcnt lgkmcnt(2)
    ds_read_b64_tr_b16 v[48:49], v21 offset:22528
    ds_read_b64_tr_b16 v[50:51], v21 offset:23040
    v_mfma_f32_32x32x16_bf16 v[96:111], v[56:59], a[16:19], v[96:111]
    buffer_load_dwordx4 v3, s[12:15], s29 offen offset:3072 lds
    v_cndmask_b32 v248, v44, v45, s[64:65]
    v_cvt_pk_bf16_f32 v248, v248, v248
    v_and_b32 v248, 0xffff0000, v248
    v_mul_f32 v248, 0xbfb8aa3b, v248
    v_mfma_f32_32x32x16_bf16 v[112:127], v[56:59], a[20:23], v[112:127]
    v_exp_f32 v248, v248
    s_nop 0
    v_add_f32 v248, 1.0, v248
    s_waitcnt lgkmcnt(2)
    ds_read_b64_tr_b16 v[52:53], v22 offset:22528
    ds_read_b64_tr_b16 v[54:55], v22 offset:23040
    v_mfma_f32_32x32x16_bf16 v[96:111], v[60:63], a[24:27], v[96:111]
    s_add_u32 m0, s36, 6144
    s_add_u32 s53, s38, 880768
    buffer_load_dwordx4 v6, s[8:11], s53 offen lds
    v_rcp_f32 v248, v248
    s_nop 0
    v_cvt_pk_bf16_f32 v248, v248, v248
    v_and_b32 v248, 0xffff0000, v248
    v_mfma_f32_32x32x16_bf16 v[112:127], v[60:63], a[28:31], v[112:127]
    v_sub_f32 v248, 1.0, v248
    v_cvt_pk_bf16_f32 v248, v248, v248
    v_and_b32 v248, 0xffff0000, v248
    v_max_f32 v248, 0x0da24260, v248
    s_waitcnt lgkmcnt(2)
    ds_read_b64_tr_b16 v[56:57], v23 offset:22528
    ds_read_b64_tr_b16 v[58:59], v23 offset:23040
    v_mfma_f32_32x32x16_bf16 v[96:111], v[48:51], a[32:35], v[96:111]
    buffer_load_dwordx4 v7, s[8:11], s53 offen offset:1024 lds
    v_rcp_f32 v28, v248
    s_nop 0
    v_add_u32 v34, s36, v33
    ds_write_b32 v34, v28 offset:1024
    v_mfma_f32_32x32x16_bf16 v[112:127], v[48:51], a[36:39], v[112:127]
    v_mul_f32 v240, s68, v64
    v_mul_f32 v241, s68, v65
    v_mul_f32 v242, s68, v66
    v_mul_f32 v243, s68, v67
    s_waitcnt lgkmcnt(3)
    ds_read_b64_tr_b16 v[60:61], v24 offset:22528
    ds_read_b64_tr_b16 v[62:63], v24 offset:23040
    v_mfma_f32_32x32x16_bf16 v[96:111], v[52:55], a[40:43], v[96:111]
    s_add_u32 m0, s36, 8192
    s_add_u32 s53, s38, 1056896
    buffer_load_dwordx4 v6, s[8:11], s53 offen lds
    v_exp_f32 v240, v240
    v_exp_f32 v241, v241
    v_mfma_f32_32x32x16_bf16 v[112:127], v[52:55], a[44:47], v[112:127]
    v_exp_f32 v242, v242
    v_exp_f32 v243, v243
    v_fma_f32 v240, v240, v28, v28
    s_waitcnt lgkmcnt(3)
    s_waitcnt vmcnt(13) lgkmcnt(2)
    s_barrier
    s_xor_b32 s54, s3, 1
    s_mul_i32 s54, s54, 40960
    v_add_u32 v34, s54, v33
    ds_read_b32 v29, v34 offset:1024
    ds_read_b64_tr_b16 v[48:49], v21 offset:24576
    ds_read_b64_tr_b16 v[50:51], v21 offset:25088
    v_mfma_f32_32x32x16_bf16 v[96:111], v[56:59], a[48:51], v[96:111]
    buffer_load_dwordx4 v7, s[8:11], s53 offen offset:1024 lds
    v_fma_f32 v241, v241, v28, v28
    v_fma_f32 v242, v242, v28, v28
    v_fma_f32 v243, v243, v28, v28
    v_rcp_f32 v240, v240
    v_mfma_f32_32x32x16_bf16 v[112:127], v[56:59], a[52:55], v[112:127]
    v_rcp_f32 v241, v241
    v_rcp_f32 v242, v242
    s_waitcnt lgkmcnt(3)
    ds_read_b64_tr_b16 v[52:53], v22 offset:24576
    ds_read_b64_tr_b16 v[54:55], v22 offset:25088
    v_mfma_f32_32x32x16_bf16 v[96:111], v[60:63], a[56:59], v[96:111]
    s_add_u32 m0, s36, 28672
    s_nop 0
    buffer_load_dwordx4 v10, s[12:15], s30 offen lds
    v_rcp_f32 v243, v243
    v_mul_f32 v240, v64, v240
    v_mul_f32 v241, v65, v241
    v_mul_f32 v242, v66, v242
    v_mfma_f32_32x32x16_bf16 v[112:127], v[60:63], a[60:63], v[112:127]
    v_mul_f32 v243, v67, v243
    v_mul_f32 v244, s68, v68
    v_mul_f32 v245, s68, v69
    v_mul_f32 v246, s68, v70
    v_mul_f32 v247, s68, v71
    s_waitcnt lgkmcnt(2)
    ds_read_b64_tr_b16 v[56:57], v23 offset:24576
    ds_read_b64_tr_b16 v[58:59], v23 offset:25088
    v_mfma_f32_32x32x16_bf16 v[96:111], v[48:51], a[64:67], v[96:111]
    buffer_load_dwordx4 v11, s[12:15], s30 offen offset:1024 lds
    v_exp_f32 v244, v244
    v_exp_f32 v245, v245
    v_mfma_f32_32x32x16_bf16 v[112:127], v[48:51], a[68:71], v[112:127]
    v_exp_f32 v246, v246
    v_exp_f32 v247, v247
    v_fma_f32 v244, v244, v28, v28
    s_waitcnt lgkmcnt(2)
    ds_read_b64_tr_b16 v[60:61], v24 offset:24576
    ds_read_b64_tr_b16 v[62:63], v24 offset:25088
    v_mfma_f32_32x32x16_bf16 v[96:111], v[52:55], a[72:75], v[96:111]
    v_fma_f32 v245, v245, v28, v28
    v_fma_f32 v246, v246, v28, v28
    v_fma_f32 v247, v247, v28, v28
    v_rcp_f32 v244, v244
    v_rcp_f32 v245, v245
    v_mfma_f32_32x32x16_bf16 v[112:127], v[52:55], a[76:79], v[112:127]
    v_rcp_f32 v246, v246
    v_rcp_f32 v247, v247
    v_mul_f32 v244, v68, v244
    s_waitcnt lgkmcnt(2)
    ds_read_b64_tr_b16 v[48:49], v21 offset:2048
    ds_read_b64_tr_b16 v[50:51], v21 offset:2560
    v_mfma_f32_32x32x16_bf16 v[96:111], v[56:59], a[80:83], v[96:111]
    buffer_load_dwordx4 v2, s[12:15], s30 offen offset:2048 lds
    v_mul_f32 v245, v69, v245
    v_mul_f32 v246, v70, v246
    v_mul_f32 v247, v71, v247
    v_cvt_pk_bf16_f32 v160, v240, v241
    v_cvt_pk_bf16_f32 v161, v242, v243
    v_mfma_f32_32x32x16_bf16 v[112:127], v[56:59], a[84:87], v[112:127]
    v_cvt_pk_bf16_f32 v162, v244, v245
    v_cvt_pk_bf16_f32 v163, v246, v247
    buffer_store_dwordx4 v[160:163], v27, s[20:23], s48 offen sc1
    s_waitcnt lgkmcnt(2)
    ds_read_b64_tr_b16 v[52:53], v22 offset:2048
    ds_read_b64_tr_b16 v[54:55], v22 offset:2560
    v_mfma_f32_32x32x16_bf16 v[96:111], v[60:63], a[88:91], v[96:111]
    buffer_load_dwordx4 v3, s[12:15], s30 offen offset:3072 lds
    v_mul_f32 v240, s68, v72
    v_mul_f32 v241, s68, v73
    v_mul_f32 v242, s68, v74
    v_mul_f32 v243, s68, v75
    v_mfma_f32_32x32x16_bf16 v[112:127], v[60:63], a[92:95], v[112:127]
    v_exp_f32 v240, v240
    v_exp_f32 v241, v241
    s_waitcnt lgkmcnt(2)
    ds_read_b64_tr_b16 v[56:57], v23 offset:2048
    ds_read_b64_tr_b16 v[58:59], v23 offset:2560
    v_mfma_f32_32x32x16_bf16 v[96:111], v[48:51], a[96:99], v[96:111]
    s_add_u32 m0, s36, 10240
    s_add_u32 s53, s38, 1233024
    buffer_load_dwordx4 v6, s[8:11], s53 offen lds
    v_exp_f32 v242, v242
    v_exp_f32 v243, v243
    v_fma_f32 v240, v240, v28, v28
    v_mfma_f32_32x32x16_bf16 v[112:127], v[48:51], a[100:103], v[112:127]
    v_fma_f32 v241, v241, v28, v28
    v_fma_f32 v242, v242, v28, v28
    v_fma_f32 v243, v243, v28, v28
    v_rcp_f32 v240, v240
    s_waitcnt lgkmcnt(2)
    ds_read_b64_tr_b16 v[60:61], v24 offset:2048
    ds_read_b64_tr_b16 v[62:63], v24 offset:2560
    v_mfma_f32_32x32x16_bf16 v[96:111], v[52:55], a[104:107], v[96:111]
    buffer_load_dwordx4 v7, s[8:11], s53 offen offset:1024 lds
    v_rcp_f32 v241, v241
    v_rcp_f32 v242, v242
    v_mfma_f32_32x32x16_bf16 v[112:127], v[52:55], a[108:111], v[112:127]
    v_rcp_f32 v243, v243
    v_mul_f32 v240, v72, v240
    v_mul_f32 v241, v73, v241
    v_mul_f32 v242, v74, v242
    s_waitcnt lgkmcnt(2)
    s_waitcnt vmcnt(9)
    s_barrier
    ds_read_b64_tr_b16 v[48:49], v21 offset:4096
    ds_read_b64_tr_b16 v[50:51], v21 offset:4608
    v_mfma_f32_32x32x16_bf16 v[96:111], v[56:59], a[112:115], v[96:111]
    s_add_u32 m0, s36, 12288
    s_add_u32 s53, s38, 256
    buffer_load_dwordx4 v8, s[8:11], s53 offen lds
    v_mul_f32 v243, v75, v243
    v_mul_f32 v244, s68, v76
    v_mul_f32 v245, s68, v77
    v_mul_f32 v246, s68, v78
    v_mul_f32 v247, s68, v79
    v_mfma_f32_32x32x16_bf16 v[112:127], v[56:59], a[116:119], v[112:127]
    v_exp_f32 v244, v244
    v_exp_f32 v245, v245
    s_waitcnt lgkmcnt(2)
    ds_read_b64_tr_b16 v[52:53], v22 offset:4096
    ds_read_b64_tr_b16 v[54:55], v22 offset:4608
    v_mfma_f32_32x32x16_bf16 v[96:111], v[60:63], a[120:123], v[96:111]
    buffer_load_dwordx4 v9, s[8:11], s53 offen offset:1024 lds
    v_exp_f32 v246, v246
    v_exp_f32 v247, v247
    v_fma_f32 v244, v244, v28, v28
    v_mfma_f32_32x32x16_bf16 v[112:127], v[60:63], a[124:127], v[112:127]
    v_fma_f32 v245, v245, v28, v28
    v_fma_f32 v246, v246, v28, v28
    v_fma_f32 v247, v247, v28, v28
    v_rcp_f32 v244, v244
    s_waitcnt lgkmcnt(2)
    ds_read_b64_tr_b16 v[56:57], v23 offset:4096
    ds_read_b64_tr_b16 v[58:59], v23 offset:4608
    v_mfma_f32_32x32x16_bf16 v[96:111], v[48:51], a[128:131], v[96:111]
    s_add_u32 m0, s36, 14336
    s_add_u32 s53, s38, 176384
    buffer_load_dwordx4 v8, s[8:11], s53 offen lds
    v_rcp_f32 v245, v245
    v_rcp_f32 v246, v246
    v_mfma_f32_32x32x16_bf16 v[112:127], v[48:51], a[132:135], v[112:127]
    v_rcp_f32 v247, v247
    v_mul_f32 v244, v76, v244
    v_mul_f32 v245, v77, v245
    v_mul_f32 v246, v78, v246
    s_waitcnt lgkmcnt(2)
    ds_read_b64_tr_b16 v[60:61], v24 offset:4096
    ds_read_b64_tr_b16 v[62:63], v24 offset:4608
    v_mfma_f32_32x32x16_bf16 v[96:111], v[52:55], a[136:139], v[96:111]
    buffer_load_dwordx4 v9, s[8:11], s53 offen offset:1024 lds
    v_mul_f32 v247, v79, v247
    v_cvt_pk_bf16_f32 v164, v240, v241
    v_cvt_pk_bf16_f32 v165, v242, v243
    v_cvt_pk_bf16_f32 v166, v244, v245
    v_cvt_pk_bf16_f32 v167, v246, v247
    v_mfma_f32_32x32x16_bf16 v[112:127], v[52:55], a[140:143], v[112:127]
    buffer_store_dwordx4 v[164:167], v27, s[20:23], s48 offen offset:2048 sc1
    s_waitcnt lgkmcnt(2)
    ds_read_b64_tr_b16 v[48:49], v21 offset:6144
    ds_read_b64_tr_b16 v[50:51], v21 offset:6656
    v_mfma_f32_32x32x16_bf16 v[96:111], v[56:59], a[144:147], v[96:111]
    s_add_u32 m0, s36, 24576
    s_nop 0
    buffer_load_dwordx4 v10, s[12:15], s31 offen lds
    v_mul_f32 v240, s68, v80
    v_mul_f32 v241, s68, v81
    v_mul_f32 v242, s68, v82
    v_mul_f32 v243, s68, v83
    v_mfma_f32_32x32x16_bf16 v[112:127], v[56:59], a[148:151], v[112:127]
    v_exp_f32 v240, v240
    v_exp_f32 v241, v241
    s_waitcnt lgkmcnt(2)
    ds_read_b64_tr_b16 v[52:53], v22 offset:6144
    ds_read_b64_tr_b16 v[54:55], v22 offset:6656
    v_mfma_f32_32x32x16_bf16 v[96:111], v[60:63], a[152:155], v[96:111]
    v_exp_f32 v242, v242
    v_exp_f32 v243, v243
    v_fma_f32 v240, v240, v29, v29
    v_fma_f32 v241, v241, v29, v29
    v_fma_f32 v242, v242, v29, v29
    v_fma_f32 v243, v243, v29, v29
    v_mfma_f32_32x32x16_bf16 v[112:127], v[60:63], a[156:159], v[112:127]
    v_rcp_f32 v240, v240
    v_rcp_f32 v241, v241
    s_waitcnt lgkmcnt(2)
    ds_read_b64_tr_b16 v[56:57], v23 offset:6144
    ds_read_b64_tr_b16 v[58:59], v23 offset:6656
    v_mfma_f32_32x32x16_bf16 v[96:111], v[48:51], a[160:163], v[96:111]
    buffer_load_dwordx4 v11, s[12:15], s31 offen offset:1024 lds
    v_rcp_f32 v242, v242
    v_rcp_f32 v243, v243
    v_mul_f32 v240, v80, v240
    v_mfma_f32_32x32x16_bf16 v[112:127], v[48:51], a[164:167], v[112:127]
    v_mul_f32 v241, v81, v241
    v_mul_f32 v242, v82, v242
    v_mul_f32 v243, v83, v243
    v_mul_f32 v244, s68, v84
    v_mul_f32 v245, s68, v85
    s_waitcnt lgkmcnt(2)
    ds_read_b64_tr_b16 v[60:61], v24 offset:6144
    ds_read_b64_tr_b16 v[62:63], v24 offset:6656
    v_mfma_f32_32x32x16_bf16 v[96:111], v[52:55], a[168:171], v[96:111]
    buffer_load_dwordx4 v2, s[12:15], s31 offen offset:2048 lds
    v_mul_f32 v246, s68, v86
    v_mul_f32 v247, s68, v87
    v_exp_f32 v244, v244
    v_mfma_f32_32x32x16_bf16 v[112:127], v[52:55], a[172:175], v[112:127]
    v_exp_f32 v245, v245
    v_exp_f32 v246, v246
    s_waitcnt lgkmcnt(2)
    s_waitcnt vmcnt(8)
    s_barrier
    ds_read_b64_tr_b16 v[48:49], v21 offset:8192
    ds_read_b64_tr_b16 v[50:51], v21 offset:8704
    v_mfma_f32_32x32x16_bf16 v[96:111], v[56:59], a[176:179], v[96:111]
    buffer_load_dwordx4 v3, s[12:15], s31 offen offset:3072 lds
    v_exp_f32 v247, v247
    v_fma_f32 v244, v244, v29, v29
    v_fma_f32 v245, v245, v29, v29
    v_fma_f32 v246, v246, v29, v29
    v_fma_f32 v247, v247, v29, v29
    v_mfma_f32_32x32x16_bf16 v[112:127], v[56:59], a[180:183], v[112:127]
    v_rcp_f32 v244, v244
    v_rcp_f32 v245, v245
    s_waitcnt lgkmcnt(2)
    ds_read_b64_tr_b16 v[52:53], v22 offset:8192
    ds_read_b64_tr_b16 v[54:55], v22 offset:8704
    v_mfma_f32_32x32x16_bf16 v[96:111], v[60:63], a[184:187], v[96:111]
    s_add_u32 m0, s36, 2048
    s_add_u32 s53, s38, 352512
    buffer_load_dwordx4 v8, s[8:11], s53 offen lds
    v_rcp_f32 v246, v246
    v_rcp_f32 v247, v247
    v_mul_f32 v244, v84, v244
    v_mul_f32 v245, v85, v245
    v_mfma_f32_32x32x16_bf16 v[112:127], v[60:63], a[188:191], v[112:127]
    v_mul_f32 v246, v86, v246
    v_mul_f32 v247, v87, v247
    v_cvt_pk_bf16_f32 v168, v240, v241
    v_cvt_pk_bf16_f32 v169, v242, v243
    v_cvt_pk_bf16_f32 v170, v244, v245
    s_waitcnt lgkmcnt(2)
    ds_read_b64_tr_b16 v[56:57], v23 offset:8192
    ds_read_b64_tr_b16 v[58:59], v23 offset:8704
    v_mfma_f32_32x32x16_bf16 v[96:111], v[48:51], a[192:195], v[96:111]
    buffer_load_dwordx4 v9, s[8:11], s53 offen offset:1024 lds
    v_cvt_pk_bf16_f32 v171, v246, v247
    buffer_store_dwordx4 v[168:171], v27, s[20:23], s49 offen sc1
    v_mfma_f32_32x32x16_bf16 v[112:127], v[48:51], a[196:199], v[112:127]
    v_mul_f32 v240, s68, v88
    v_mul_f32 v241, s68, v89
    v_mul_f32 v242, s68, v90
    v_mul_f32 v243, s68, v91
    s_waitcnt lgkmcnt(2)
    ds_read_b64_tr_b16 v[60:61], v24 offset:8192
    ds_read_b64_tr_b16 v[62:63], v24 offset:8704
    v_mfma_f32_32x32x16_bf16 v[96:111], v[52:55], a[200:203], v[96:111]
    s_add_u32 m0, s36, 4096
    s_add_u32 s53, s38, 528640
    buffer_load_dwordx4 v8, s[8:11], s53 offen lds
    v_exp_f32 v240, v240
    v_exp_f32 v241, v241
    v_exp_f32 v242, v242
    v_mfma_f32_32x32x16_bf16 v[112:127], v[52:55], a[204:207], v[112:127]
    v_exp_f32 v243, v243
    v_fma_f32 v240, v240, v29, v29
    v_fma_f32 v241, v241, v29, v29
    v_fma_f32 v242, v242, v29, v29
    s_waitcnt lgkmcnt(2)
    ds_read_b64_tr_b16 v[48:49], v21 offset:10240
    ds_read_b64_tr_b16 v[50:51], v21 offset:10752
    v_mfma_f32_32x32x16_bf16 v[96:111], v[56:59], a[208:211], v[96:111]
    buffer_load_dwordx4 v9, s[8:11], s53 offen offset:1024 lds
    v_fma_f32 v243, v243, v29, v29
    v_rcp_f32 v240, v240
    v_rcp_f32 v241, v241
    v_mfma_f32_32x32x16_bf16 v[112:127], v[56:59], a[212:215], v[112:127]
    v_rcp_f32 v242, v242
    v_rcp_f32 v243, v243
    v_mul_f32 v240, v88, v240
    s_waitcnt lgkmcnt(2)
    ds_read_b64_tr_b16 v[52:53], v22 offset:10240
    ds_read_b64_tr_b16 v[54:55], v22 offset:10752
    v_mfma_f32_32x32x16_bf16 v[96:111], v[60:63], a[216:219], v[96:111]
    s_add_u32 m0, s36, 20480
    s_add_u32 s53, s28, 65536
    buffer_load_dwordx4 v10, s[12:15], s53 offen lds
    v_mul_f32 v241, v89, v241
    v_mul_f32 v242, v90, v242
    v_mul_f32 v243, v91, v243
    v_mul_f32 v244, s68, v92
    v_mul_f32 v245, s68, v93
    v_mfma_f32_32x32x16_bf16 v[112:127], v[60:63], a[220:223], v[112:127]
    v_mul_f32 v246, s68, v94
    v_mul_f32 v247, s68, v95
    v_exp_f32 v244, v244
    s_waitcnt lgkmcnt(2)
    ds_read_b64_tr_b16 v[56:57], v23 offset:10240
    ds_read_b64_tr_b16 v[58:59], v23 offset:10752
    v_mfma_f32_32x32x16_bf16 v[96:111], v[48:51], a[224:227], v[96:111]
    buffer_load_dwordx4 v11, s[12:15], s53 offen offset:1024 lds
    v_exp_f32 v245, v245
    v_exp_f32 v246, v246
    v_exp_f32 v247, v247
    v_mfma_f32_32x32x16_bf16 v[112:127], v[48:51], a[228:231], v[112:127]
    v_fma_f32 v244, v244, v29, v29
    v_fma_f32 v245, v245, v29, v29
    v_fma_f32 v246, v246, v29, v29
    v_fma_f32 v247, v247, v29, v29
    s_waitcnt lgkmcnt(2)
    ds_read_b64_tr_b16 v[60:61], v24 offset:10240
    ds_read_b64_tr_b16 v[62:63], v24 offset:10752
    v_mfma_f32_32x32x16_bf16 v[96:111], v[52:55], a[232:235], v[96:111]
    v_rcp_f32 v244, v244
    v_rcp_f32 v245, v245
    v_rcp_f32 v246, v246
    v_rcp_f32 v247, v247
    v_mul_f32 v244, v92, v244
    v_mfma_f32_32x32x16_bf16 v[112:127], v[52:55], a[236:239], v[112:127]
    v_mul_f32 v245, v93, v245
    v_mul_f32 v246, v94, v246
    v_mul_f32 v247, v95, v247
    s_waitcnt lgkmcnt(2)
    s_waitcnt vmcnt(12)
    s_barrier
    ds_read_b64_tr_b16 v[48:49], v21 offset:12288
    ds_read_b64_tr_b16 v[50:51], v21 offset:12800
    v_mfma_f32_32x32x16_bf16 v[96:111], v[56:59], a[240:243], v[96:111]
    buffer_load_dwordx4 v2, s[12:15], s53 offen offset:2048 lds
    v_cvt_pk_bf16_f32 v172, v240, v241
    v_cvt_pk_bf16_f32 v173, v242, v243
    v_cvt_pk_bf16_f32 v174, v244, v245
    v_cvt_pk_bf16_f32 v175, v246, v247
    v_mfma_f32_32x32x16_bf16 v[112:127], v[56:59], a[244:247], v[112:127]
    buffer_store_dwordx4 v[172:175], v27, s[20:23], s49 offen offset:2048 sc1
    s_waitcnt lgkmcnt(2)
    ds_read_b64_tr_b16 v[52:53], v22 offset:12288
    ds_read_b64_tr_b16 v[54:55], v22 offset:12800
    v_mfma_f32_32x32x16_bf16 v[96:111], v[60:63], a[248:251], v[96:111]
    buffer_load_dwordx4 v3, s[12:15], s53 offen offset:3072 lds
    v_mfma_f32_32x32x16_bf16 v[112:127], v[60:63], a[252:255], v[112:127]
    s_waitcnt lgkmcnt(2)
    ds_read_b64_tr_b16 v[56:57], v23 offset:12288
    ds_read_b64_tr_b16 v[58:59], v23 offset:12800
    v_mfma_f32_32x32x16_bf16 v[64:79], v[48:51], a[0:3], 0
    s_add_u32 m0, s36, 6144
    s_add_u32 s53, s38, 704768
    buffer_load_dwordx4 v8, s[8:11], s53 offen lds
    v_mfma_f32_32x32x16_bf16 v[80:95], v[48:51], a[4:7], 0
    buffer_load_dwordx4 v9, s[8:11], s53 offen offset:1024 lds
    s_waitcnt lgkmcnt(2)
    ds_read_b64_tr_b16 v[60:61], v24 offset:12288
    ds_read_b64_tr_b16 v[62:63], v24 offset:12800
    v_mfma_f32_32x32x16_bf16 v[64:79], v[52:55], a[8:11], v[64:79]
    s_add_u32 m0, s36, 8192
    s_add_u32 s53, s38, 880896
    buffer_load_dwordx4 v8, s[8:11], s53 offen lds
    v_mfma_f32_32x32x16_bf16 v[80:95], v[52:55], a[12:15], v[80:95]
    s_waitcnt lgkmcnt(2)
    ds_read_b64_tr_b16 v[48:49], v21 offset:14336
    ds_read_b64_tr_b16 v[50:51], v21 offset:14848
    v_mfma_f32_32x32x16_bf16 v[64:79], v[56:59], a[16:19], v[64:79]
    buffer_load_dwordx4 v9, s[8:11], s53 offen offset:1024 lds
    ds_read_b64_tr_b16 a[0:1], v25 offset:36864
    ds_read_b64_tr_b16 a[2:3], v25 offset:37888
    ds_read_b64_tr_b16 a[4:5], v26 offset:36864
    ds_read_b64_tr_b16 a[6:7], v26 offset:37888
    v_mul_f32 v240, s68, v96
    v_mul_f32 v241, s68, v97
    v_mul_f32 v242, s68, v98
    v_mul_f32 v243, s68, v99
    v_exp_f32 v240, v240
    v_mfma_f32_32x32x16_bf16 v[80:95], v[56:59], a[20:23], v[80:95]
    v_exp_f32 v241, v241
    v_exp_f32 v242, v242
    v_exp_f32 v243, v243
    s_waitcnt lgkmcnt(6)
    ds_read_b64_tr_b16 v[52:53], v22 offset:14336
    ds_read_b64_tr_b16 v[54:55], v22 offset:14848
    v_mfma_f32_32x32x16_bf16 v[64:79], v[60:63], a[24:27], v[64:79]
    s_add_u32 m0, s36, 16384
    s_add_u32 s53, s29, 65536
    buffer_load_dwordx4 v10, s[12:15], s53 offen lds
    ds_read_b64_tr_b16 a[8:9], v25 offset:38912
    ds_read_b64_tr_b16 a[10:11], v25 offset:39936
    ds_read_b64_tr_b16 a[12:13], v26 offset:38912
    ds_read_b64_tr_b16 a[14:15], v26 offset:39936
    v_fma_f32 v240, v240, v28, v28
    v_fma_f32 v241, v241, v28, v28
    v_fma_f32 v242, v242, v28, v28
    v_fma_f32 v243, v243, v28, v28
    v_rcp_f32 v240, v240
    v_mfma_f32_32x32x16_bf16 v[80:95], v[60:63], a[28:31], v[80:95]
    v_rcp_f32 v241, v241
    v_rcp_f32 v242, v242
    v_rcp_f32 v243, v243
    s_waitcnt lgkmcnt(10)
    ds_read_b64_tr_b16 v[56:57], v23 offset:14336
    ds_read_b64_tr_b16 v[58:59], v23 offset:14848
    v_mfma_f32_32x32x16_bf16 v[64:79], v[48:51], a[32:35], v[64:79]
    buffer_load_dwordx4 v11, s[12:15], s53 offen offset:1024 lds
    ds_read_b64_tr_b16 a[16:17], v25 offset:32768
    ds_read_b64_tr_b16 a[18:19], v25 offset:33792
    ds_read_b64_tr_b16 a[20:21], v26 offset:32768
    ds_read_b64_tr_b16 a[22:23], v26 offset:33792
    v_mul_f32 v240, v96, v240
    v_mul_f32 v241, v97, v241
    v_mul_f32 v242, v98, v242
    v_mul_f32 v243, v99, v243
    v_mul_f32 v244, s68, v100
    v_mul_f32 v245, s68, v101
    v_mul_f32 v246, s68, v102
    v_mfma_f32_32x32x16_bf16 v[80:95], v[48:51], a[36:39], v[80:95]
    buffer_load_dwordx4 v2, s[12:15], s53 offen offset:2048 lds
    v_mul_f32 v247, s68, v103
    v_exp_f32 v244, v244
    s_waitcnt lgkmcnt(10)
    ds_read_b64_tr_b16 v[60:61], v24 offset:14336
    ds_read_b64_tr_b16 v[62:63], v24 offset:14848
    v_mfma_f32_32x32x16_bf16 v[64:79], v[52:55], a[40:43], v[64:79]
    buffer_load_dwordx4 v3, s[12:15], s53 offen offset:3072 lds
    ds_read_b64_tr_b16 a[24:25], v25 offset:34816
    ds_read_b64_tr_b16 a[26:27], v25 offset:35840
    ds_read_b64_tr_b16 a[28:29], v26 offset:34816
    ds_read_b64_tr_b16 a[30:31], v26 offset:35840
    v_exp_f32 v245, v245
    v_exp_f32 v246, v246
    v_exp_f32 v247, v247
    v_fma_f32 v244, v244, v28, v28
    v_mfma_f32_32x32x16_bf16 v[80:95], v[52:55], a[44:47], v[80:95]
    v_fma_f32 v245, v245, v28, v28
    v_fma_f32 v246, v246, v28, v28
    v_fma_f32 v247, v247, v28, v28
    v_rcp_f32 v244, v244
    s_waitcnt lgkmcnt(10)
    s_waitcnt vmcnt(13)
    s_barrier
    ds_read_b64_tr_b16 v[48:49], v21 offset:2048
    ds_read_b64_tr_b16 v[50:51], v21 offset:2560
    v_mfma_f32_32x32x16_bf16 v[64:79], v[56:59], a[48:51], v[64:79]
    s_add_u32 m0, s36, 10240
    s_add_u32 s53, s38, 1057024
    buffer_load_dwordx4 v8, s[8:11], s53 offen lds
    ds_read_b64_tr_b16 a[32:33], v25 offset:28672
    ds_read_b64_tr_b16 a[34:35], v25 offset:29696
    ds_read_b64_tr_b16 a[36:37], v26 offset:28672
    ds_read_b64_tr_b16 a[38:39], v26 offset:29696
    v_rcp_f32 v245, v245
    v_rcp_f32 v246, v246
    v_rcp_f32 v247, v247
    v_mul_f32 v244, v100, v244
    v_mfma_f32_32x32x16_bf16 v[80:95], v[56:59], a[52:55], v[80:95]
    v_mul_f32 v245, v101, v245
    v_mul_f32 v246, v102, v246
    v_mul_f32 v247, v103, v247
    v_cvt_pk_bf16_f32 v176, v240, v241
    v_cvt_pk_bf16_f32 v177, v242, v243
    v_cvt_pk_bf16_f32 v178, v244, v245
    s_waitcnt lgkmcnt(10)
    ds_read_b64_tr_b16 v[52:53], v22 offset:2048
    ds_read_b64_tr_b16 v[54:55], v22 offset:2560
    v_mfma_f32_32x32x16_bf16 v[64:79], v[60:63], a[56:59], v[64:79]
    buffer_load_dwordx4 v9, s[8:11], s53 offen offset:1024 lds
    ds_read_b64_tr_b16 a[40:41], v25 offset:30720
    ds_read_b64_tr_b16 a[42:43], v25 offset:31744
    ds_read_b64_tr_b16 a[44:45], v26 offset:30720
    ds_read_b64_tr_b16 a[46:47], v26 offset:31744
    v_cvt_pk_bf16_f32 v179, v246, v247
    s_add_u32 s55, s48, 8192
    buffer_store_dwordx4 v[176:179], v27, s[20:23], s55 offen sc1
    v_mul_f32 v240, s68, v104
    v_mul_f32 v241, s68, v105
    v_mfma_f32_32x32x16_bf16 v[80:95], v[60:63], a[60:63], v[80:95]
    v_mul_f32 v242, s68, v106
    v_mul_f32 v243, s68, v107
    v_exp_f32 v240, v240
    s_waitcnt vmcnt(12)
    s_add_u32 s54, s51, 1
    v_mov_b32 v34, s54
    v_mov_b32 v35, s52
    v_mov_b32 v36, 0
    s_mov_b64 exec, 1
    buffer_store_dwordx2 v[34:35], v36, s[20:23], s50 offen sc1
    s_mov_b64 exec, -1
    s_waitcnt lgkmcnt(10)
    ds_read_b64_tr_b16 v[56:57], v23 offset:2048
    ds_read_b64_tr_b16 v[58:59], v23 offset:2560
    v_mfma_f32_32x32x16_bf16 v[64:79], v[48:51], a[64:67], v[64:79]
    s_add_u32 m0, s36, 12288
    s_add_u32 s53, s38, 1233152
    buffer_load_dwordx4 v8, s[8:11], s53 offen lds
    ds_read_b64_tr_b16 a[48:49], v25 offset:24576
    ds_read_b64_tr_b16 a[50:51], v25 offset:25600
    ds_read_b64_tr_b16 a[52:53], v26 offset:24576
    ds_read_b64_tr_b16 a[54:55], v26 offset:25600
    v_exp_f32 v241, v241
    v_exp_f32 v242, v242
    v_exp_f32 v243, v243
    v_fma_f32 v240, v240, v28, v28
    v_mfma_f32_32x32x16_bf16 v[80:95], v[48:51], a[68:71], v[80:95]
    buffer_load_dwordx4 v9, s[8:11], s53 offen offset:1024 lds
    v_fma_f32 v241, v241, v28, v28
    v_fma_f32 v242, v242, v28, v28
    s_waitcnt lgkmcnt(10)
    ds_read_b64_tr_b16 v[60:61], v24 offset:2048
    ds_read_b64_tr_b16 v[62:63], v24 offset:2560
    v_mfma_f32_32x32x16_bf16 v[64:79], v[52:55], a[72:75], v[64:79]
    s_add_u32 m0, s36, 36864
    s_add_u32 s53, s30, 65536
    buffer_load_dwordx4 v10, s[12:15], s53 offen lds
    ds_read_b64_tr_b16 a[56:57], v25 offset:26624
    ds_read_b64_tr_b16 a[58:59], v25 offset:27648
    ds_read_b64_tr_b16 a[60:61], v26 offset:26624
    ds_read_b64_tr_b16 a[62:63], v26 offset:27648
    v_fma_f32 v243, v243, v28, v28
    v_rcp_f32 v240, v240
    v_rcp_f32 v241, v241
    v_rcp_f32 v242, v242
    v_mfma_f32_32x32x16_bf16 v[80:95], v[52:55], a[76:79], v[80:95]
    v_rcp_f32 v243, v243
    v_mul_f32 v240, v104, v240
    v_mul_f32 v241, v105, v241
    v_mul_f32 v242, v106, v242
    s_waitcnt lgkmcnt(10)
    ds_read_b64_tr_b16 v[48:49], v21 offset:4096
    ds_read_b64_tr_b16 v[50:51], v21 offset:4608
    v_mfma_f32_32x32x16_bf16 v[64:79], v[56:59], a[80:83], v[64:79]
    buffer_load_dwordx4 v11, s[12:15], s53 offen offset:1024 lds
    ds_read_b64_tr_b16 a[64:65], v25 offset:20480
    ds_read_b64_tr_b16 a[66:67], v25 offset:21504
    ds_read_b64_tr_b16 a[68:69], v26 offset:20480
    ds_read_b64_tr_b16 a[70:71], v26 offset:21504
    v_mul_f32 v243, v107, v243
    v_mul_f32 v244, s68, v108
    v_mul_f32 v245, s68, v109
    v_mul_f32 v246, s68, v110
    v_mul_f32 v247, s68, v111
    v_mfma_f32_32x32x16_bf16 v[80:95], v[56:59], a[84:87], v[80:95]
    v_exp_f32 v244, v244
    v_exp_f32 v245, v245
    s_waitcnt lgkmcnt(10)
    ds_read_b64_tr_b16 v[52:53], v22 offset:4096
    ds_read_b64_tr_b16 v[54:55], v22 offset:4608
    v_mfma_f32_32x32x16_bf16 v[64:79], v[60:63], a[88:91], v[64:79]
    buffer_load_dwordx4 v2, s[12:15], s53 offen offset:2048 lds
    s_waitcnt vmcnt(17)
    ds_read_b64_tr_b16 a[72:73], v25 offset:22528
    ds_read_b64_tr_b16 a[74:75], v25 offset:23552
    ds_read_b64_tr_b16 a[76:77], v26 offset:22528
    ds_read_b64_tr_b16 a[78:79], v26 offset:23552
    v_exp_f32 v246, v246
    v_exp_f32 v247, v247
    v_fma_f32 v244, v244, v28, v28
    v_fma_f32 v245, v245, v28, v28
    v_fma_f32 v246, v246, v28, v28
    v_mfma_f32_32x32x16_bf16 v[80:95], v[60:63], a[92:95], v[80:95]
    v_fma_f32 v247, v247, v28, v28
    v_rcp_f32 v244, v244
    v_rcp_f32 v245, v245
    s_waitcnt lgkmcnt(10)
    ds_read_b64_tr_b16 v[56:57], v23 offset:4096
    ds_read_b64_tr_b16 v[58:59], v23 offset:4608
    v_mfma_f32_32x32x16_bf16 v[64:79], v[48:51], a[96:99], v[64:79]
    buffer_load_dwordx4 v3, s[12:15], s53 offen offset:3072 lds
    v_rcp_f32 v246, v246
    v_rcp_f32 v247, v247
    v_mul_f32 v244, v108, v244
    v_mul_f32 v245, v109, v245
    v_mfma_f32_32x32x16_bf16 v[80:95], v[48:51], a[100:103], v[80:95]
    s_add_u32 m0, s36, 32768
    s_add_u32 s53, s31, 65536
    buffer_load_dwordx4 v10, s[12:15], s53 offen lds
    v_mul_f32 v246, v110, v246
    v_mul_f32 v247, v111, v247
    s_waitcnt lgkmcnt(6)
    ds_read_b64_tr_b16 v[60:61], v24 offset:4096
    ds_read_b64_tr_b16 v[62:63], v24 offset:4608
    v_mfma_f32_32x32x16_bf16 v[64:79], v[52:55], a[104:107], v[64:79]
    buffer_load_dwordx4 v11, s[12:15], s53 offen offset:1024 lds
    v_cvt_pk_bf16_f32 v180, v240, v241
    v_cvt_pk_bf16_f32 v181, v242, v243
    v_cvt_pk_bf16_f32 v182, v244, v245
    v_cvt_pk_bf16_f32 v183, v246, v247
    s_add_u32 s55, s48, 8192
    buffer_store_dwordx4 v[180:183], v27, s[20:23], s55 offen offset:2048 sc1
    v_mfma_f32_32x32x16_bf16 v[80:95], v[52:55], a[108:111], v[80:95]
    v_mul_f32 v240, s68, v112
    v_mul_f32 v241, s68, v113
    v_mul_f32 v242, s68, v114
    v_mul_f32 v243, s68, v115
    s_waitcnt lgkmcnt(2)
    s_waitcnt vmcnt(17)
    s_barrier
    ds_read_b64_tr_b16 v[48:49], v21 offset:6144
    ds_read_b64_tr_b16 v[50:51], v21 offset:6656
    v_mfma_f32_32x32x16_bf16 v[64:79], v[56:59], a[112:115], v[64:79]
    buffer_load_dwordx4 v2, s[12:15], s53 offen offset:2048 lds
    s_waitcnt vmcnt(16)
    ds_read_b64_tr_b16 a[80:81], v25 offset:16384
    ds_read_b64_tr_b16 a[82:83], v25 offset:17408
    ds_read_b64_tr_b16 a[84:85], v26 offset:16384
    ds_read_b64_tr_b16 a[86:87], v26 offset:17408
    v_exp_f32 v240, v240
    v_exp_f32 v241, v241
    v_exp_f32 v242, v242
    v_mfma_f32_32x32x16_bf16 v[80:95], v[56:59], a[116:119], v[80:95]
    v_exp_f32 v243, v243
    v_fma_f32 v240, v240, v29, v29
    v_fma_f32 v241, v241, v29, v29
    v_fma_f32 v242, v242, v29, v29
    s_waitcnt lgkmcnt(6)
    ds_read_b64_tr_b16 v[52:53], v22 offset:6144
    ds_read_b64_tr_b16 v[54:55], v22 offset:6656
    v_mfma_f32_32x32x16_bf16 v[64:79], v[60:63], a[120:123], v[64:79]
    buffer_load_dwordx4 v3, s[12:15], s53 offen offset:3072 lds
    v_fma_f32 v243, v243, v29, v29
    v_rcp_f32 v240, v240
    v_rcp_f32 v241, v241
    v_mfma_f32_32x32x16_bf16 v[80:95], v[60:63], a[124:127], v[80:95]
    v_rcp_f32 v242, v242
    v_rcp_f32 v243, v243
    v_mul_f32 v240, v112, v240
    s_waitcnt lgkmcnt(6)
    ds_read_b64_tr_b16 v[56:57], v23 offset:6144
    ds_read_b64_tr_b16 v[58:59], v23 offset:6656
    v_mfma_f32_32x32x16_bf16 v[64:79], v[48:51], a[128:131], v[64:79]
    s_add_u32 m0, s36, 28672
    s_add_u32 s53, s40, 131072
    buffer_load_dwordx4 v10, s[12:15], s53 offen lds
    s_waitcnt vmcnt(16)
    ds_read_b64_tr_b16 a[88:89], v25 offset:18432
    ds_read_b64_tr_b16 a[90:91], v25 offset:19456
    ds_read_b64_tr_b16 a[92:93], v26 offset:18432
    ds_read_b64_tr_b16 a[94:95], v26 offset:19456
    v_mul_f32 v241, v113, v241
    v_mul_f32 v242, v114, v242
    v_mul_f32 v243, v115, v243
    v_mul_f32 v244, s68, v116
    v_mul_f32 v245, s68, v117
    v_mul_f32 v246, s68, v118
    v_mfma_f32_32x32x16_bf16 v[80:95], v[48:51], a[132:135], v[80:95]
    buffer_load_dwordx4 v11, s[12:15], s53 offen offset:1024 lds
    v_mul_f32 v247, s68, v119
    s_waitcnt lgkmcnt(6)
    ds_read_b64_tr_b16 v[60:61], v24 offset:6144
    ds_read_b64_tr_b16 v[62:63], v24 offset:6656
    v_mfma_f32_32x32x16_bf16 v[64:79], v[52:55], a[136:139], v[64:79]
    buffer_load_dwordx4 v2, s[12:15], s53 offen offset:2048 lds
    v_exp_f32 v244, v244
    v_exp_f32 v245, v245
    v_exp_f32 v246, v246
    v_mfma_f32_32x32x16_bf16 v[80:95], v[52:55], a[140:143], v[80:95]
    v_exp_f32 v247, v247
    v_fma_f32 v244, v244, v29, v29
    v_fma_f32 v245, v245, v29, v29
    v_fma_f32 v246, v246, v29, v29
    s_waitcnt lgkmcnt(6)
    ds_read_b64_tr_b16 v[48:49], v21 offset:8192
    ds_read_b64_tr_b16 v[50:51], v21 offset:8704
    v_mfma_f32_32x32x16_bf16 v[64:79], v[56:59], a[144:147], v[64:79]
    buffer_load_dwordx4 v3, s[12:15], s53 offen offset:3072 lds
    v_fma_f32 v247, v247, v29, v29
    v_rcp_f32 v244, v244
    v_rcp_f32 v245, v245
    v_rcp_f32 v246, v246
    v_mfma_f32_32x32x16_bf16 v[80:95], v[56:59], a[148:151], v[80:95]
    v_rcp_f32 v247, v247
    v_mul_f32 v244, v116, v244
    v_mul_f32 v245, v117, v245
    v_mul_f32 v246, v118, v246
    s_waitcnt lgkmcnt(2)
    ds_read_b64_tr_b16 v[52:53], v22 offset:8192
    ds_read_b64_tr_b16 v[54:55], v22 offset:8704
    v_mfma_f32_32x32x16_bf16 v[64:79], v[60:63], a[152:155], v[64:79]
    s_add_u32 m0, s36, 24576
    s_add_u32 s53, s41, 131072
    buffer_load_dwordx4 v10, s[12:15], s53 offen lds
    v_mul_f32 v247, v119, v247
    v_cvt_pk_bf16_f32 v184, v240, v241
    v_cvt_pk_bf16_f32 v185, v242, v243
    v_cvt_pk_bf16_f32 v186, v244, v245
    v_cvt_pk_bf16_f32 v187, v246, v247
    s_add_u32 s55, s49, 8192
    buffer_store_dwordx4 v[184:187], v27, s[20:23], s55 offen sc1
    v_mfma_f32_32x32x16_bf16 v[80:95], v[60:63], a[156:159], v[80:95]
    v_mul_f32 v240, s68, v120
    v_mul_f32 v241, s68, v121
    v_mul_f32 v242, s68, v122
    v_mul_f32 v243, s68, v123
    s_waitcnt lgkmcnt(2)
    ds_read_b64_tr_b16 v[56:57], v23 offset:8192
    ds_read_b64_tr_b16 v[58:59], v23 offset:8704
    v_mfma_f32_32x32x16_bf16 v[64:79], v[48:51], a[160:163], v[64:79]
    buffer_load_dwordx4 v11, s[12:15], s53 offen offset:1024 lds
    v_exp_f32 v240, v240
    v_exp_f32 v241, v241
    v_exp_f32 v242, v242
    v_mfma_f32_32x32x16_bf16 v[80:95], v[48:51], a[164:167], v[80:95]
    buffer_load_dwordx4 v2, s[12:15], s53 offen offset:2048 lds
    v_exp_f32 v243, v243
    s_waitcnt lgkmcnt(2)
    ds_read_b64_tr_b16 v[60:61], v24 offset:8192
    ds_read_b64_tr_b16 v[62:63], v24 offset:8704
    v_mfma_f32_32x32x16_bf16 v[64:79], v[52:55], a[168:171], v[64:79]
    buffer_load_dwordx4 v3, s[12:15], s53 offen offset:3072 lds
    s_waitcnt vmcnt(16)
    ds_read_b64_tr_b16 a[96:97], v25 offset:36864
    ds_read_b64_tr_b16 a[98:99], v25 offset:37888
    ds_read_b64_tr_b16 a[100:101], v26 offset:36864
    ds_read_b64_tr_b16 a[102:103], v26 offset:37888
    v_fma_f32 v240, v240, v29, v29
    v_fma_f32 v241, v241, v29, v29
    v_fma_f32 v242, v242, v29, v29
    v_fma_f32 v243, v243, v29, v29
    v_rcp_f32 v240, v240
    v_mfma_f32_32x32x16_bf16 v[80:95], v[52:55], a[172:175], v[80:95]
    v_rcp_f32 v241, v241
    v_rcp_f32 v242, v242
    s_waitcnt lgkmcnt(6)
    s_barrier
    ds_read_b64_tr_b16 v[48:49], v21 offset:10240
    ds_read_b64_tr_b16 v[50:51], v21 offset:10752
    v_mfma_f32_32x32x16_bf16 v[64:79], v[56:59], a[176:179], v[64:79]
    s_add_u32 m0, s36, 20480
    s_nop 0
    buffer_load_dwordx4 v10, s[12:15], s42 offen lds
    v_rcp_f32 v243, v243
    v_mul_f32 v240, v120, v240
    v_mul_f32 v241, v121, v241
    v_mul_f32 v242, v122, v242
    v_mul_f32 v243, v123, v243
    v_mul_f32 v244, s68, v124
    v_mfma_f32_32x32x16_bf16 v[80:95], v[56:59], a[180:183], v[80:95]
    v_mul_f32 v245, s68, v125
    v_mul_f32 v246, s68, v126
    v_mul_f32 v247, s68, v127
    v_exp_f32 v244, v244
    s_waitcnt lgkmcnt(6)
    ds_read_b64_tr_b16 v[52:53], v22 offset:10240
    ds_read_b64_tr_b16 v[54:55], v22 offset:10752
    v_mfma_f32_32x32x16_bf16 v[64:79], v[60:63], a[184:187], v[64:79]
    buffer_load_dwordx4 v11, s[12:15], s42 offen offset:1024 lds
    s_waitcnt vmcnt(16)
    ds_read_b64_tr_b16 a[104:105], v25 offset:38912
    ds_read_b64_tr_b16 a[106:107], v25 offset:39936
    ds_read_b64_tr_b16 a[108:109], v26 offset:38912
    ds_read_b64_tr_b16 a[110:111], v26 offset:39936
    v_exp_f32 v245, v245
    v_exp_f32 v246, v246
    v_exp_f32 v247, v247
    v_mfma_f32_32x32x16_bf16 v[80:95], v[60:63], a[188:191], v[80:95]
    v_fma_f32 v244, v244, v29, v29
    v_fma_f32 v245, v245, v29, v29
    v_fma_f32 v246, v246, v29, v29
    v_fma_f32 v247, v247, v29, v29
    s_waitcnt lgkmcnt(6)
    ds_read_b64_tr_b16 v[56:57], v23 offset:10240
    ds_read_b64_tr_b16 v[58:59], v23 offset:10752
    v_mfma_f32_32x32x16_bf16 v[64:79], v[48:51], a[192:195], v[64:79]
    buffer_load_dwordx4 v2, s[12:15], s42 offen offset:2048 lds
    v_rcp_f32 v244, v244
    v_rcp_f32 v245, v245
    v_rcp_f32 v246, v246
    v_mfma_f32_32x32x16_bf16 v[80:95], v[48:51], a[196:199], v[80:95]
    buffer_load_dwordx4 v3, s[12:15], s42 offen offset:3072 lds
    s_waitcnt lgkmcnt(6)
    ds_read_b64_tr_b16 v[60:61], v24 offset:10240
    ds_read_b64_tr_b16 v[62:63], v24 offset:10752
    v_mfma_f32_32x32x16_bf16 v[64:79], v[52:55], a[200:203], v[64:79]
    s_add_u32 m0, s36, 16384
    s_lshl3_add_u32 s53, s73, s43
    buffer_load_dwordx4 v10, s[16:19], s53 offen lds
    s_waitcnt vmcnt(17)
    ds_read_b64_tr_b16 a[112:113], v25 offset:32768
    ds_read_b64_tr_b16 a[114:115], v25 offset:33792
    ds_read_b64_tr_b16 a[116:117], v26 offset:32768
    ds_read_b64_tr_b16 a[118:119], v26 offset:33792
    v_rcp_f32 v247, v247
    v_mul_f32 v244, v124, v244
    v_mul_f32 v245, v125, v245
    v_mul_f32 v246, v126, v246
    v_mul_f32 v247, v127, v247
    v_cvt_pk_bf16_f32 v188, v240, v241
    v_cvt_pk_bf16_f32 v189, v242, v243
    v_cvt_pk_bf16_f32 v190, v244, v245
    v_mfma_f32_32x32x16_bf16 v[80:95], v[52:55], a[204:207], v[80:95]
    v_cvt_pk_bf16_f32 v191, v246, v247
    s_add_u32 s55, s49, 8192
    buffer_store_dwordx4 v[188:191], v27, s[20:23], s55 offen offset:2048 sc1
    s_waitcnt lgkmcnt(6)
    ds_read_b64_tr_b16 v[48:49], v21 offset:12288
    ds_read_b64_tr_b16 v[50:51], v21 offset:12800
    v_mfma_f32_32x32x16_bf16 v[64:79], v[56:59], a[208:211], v[64:79]
    buffer_load_dwordx4 v11, s[16:19], s53 offen offset:1024 lds
    s_waitcnt vmcnt(16)
    ds_read_b64_tr_b16 a[120:121], v25 offset:34816
    ds_read_b64_tr_b16 a[122:123], v25 offset:35840
    ds_read_b64_tr_b16 a[124:125], v26 offset:34816
    ds_read_b64_tr_b16 a[126:127], v26 offset:35840
    v_mfma_f32_32x32x16_bf16 v[80:95], v[56:59], a[212:215], v[80:95]
    s_waitcnt lgkmcnt(10)
    ds_read_b64_tr_b16 v[52:53], v22 offset:12288
    ds_read_b64_tr_b16 v[54:55], v22 offset:12800
    v_mfma_f32_32x32x16_bf16 v[64:79], v[60:63], a[216:219], v[64:79]
    buffer_load_dwordx4 v2, s[16:19], s53 offen offset:2048 lds
    v_mfma_f32_32x32x16_bf16 v[80:95], v[60:63], a[220:223], v[80:95]
    buffer_load_dwordx2 v[30:31], v32, s[20:23], 0 offen offset:32 sc1
    s_waitcnt lgkmcnt(6)
    ds_read_b64_tr_b16 v[56:57], v23 offset:12288
    ds_read_b64_tr_b16 v[58:59], v23 offset:12800
    v_mfma_f32_32x32x16_bf16 v[64:79], v[48:51], a[224:227], v[64:79]
    buffer_load_dwordx4 v3, s[16:19], s53 offen offset:3072 lds
    s_waitcnt vmcnt(17)
    ds_read_b64_tr_b16 a[128:129], v25 offset:28672
    ds_read_b64_tr_b16 a[130:131], v25 offset:29696
    ds_read_b64_tr_b16 a[132:133], v26 offset:28672
    ds_read_b64_tr_b16 a[134:135], v26 offset:29696
    v_mfma_f32_32x32x16_bf16 v[80:95], v[48:51], a[228:231], v[80:95]
    s_add_u32 m0, s36, 36864
    s_lshl3_add_u32 s53, s74, s43
    buffer_load_dwordx4 v10, s[16:19], s53 offen lds
    s_waitcnt lgkmcnt(6)
    ds_read_b64_tr_b16 v[60:61], v24 offset:12288
    ds_read_b64_tr_b16 v[62:63], v24 offset:12800
    v_mfma_f32_32x32x16_bf16 v[64:79], v[52:55], a[232:235], v[64:79]
    buffer_load_dwordx4 v11, s[16:19], s53 offen offset:1024 lds
    s_waitcnt vmcnt(17)
    ds_read_b64_tr_b16 a[136:137], v25 offset:30720
    ds_read_b64_tr_b16 a[138:139], v25 offset:31744
    ds_read_b64_tr_b16 a[140:141], v26 offset:30720
    ds_read_b64_tr_b16 a[142:143], v26 offset:31744
    v_mfma_f32_32x32x16_bf16 v[80:95], v[52:55], a[236:239], v[80:95]
    s_waitcnt lgkmcnt(10)
    v_mfma_f32_32x32x16_bf16 v[64:79], v[56:59], a[240:243], v[64:79]
    buffer_load_dwordx4 v2, s[16:19], s53 offen offset:2048 lds
    v_mfma_f32_32x32x16_bf16 v[80:95], v[56:59], a[244:247], v[80:95]
    s_waitcnt lgkmcnt(4)
    v_mfma_f32_32x32x16_bf16 v[64:79], v[60:63], a[248:251], v[64:79]
    buffer_load_dwordx4 v3, s[16:19], s53 offen offset:3072 lds
    s_waitcnt vmcnt(16)
    ds_read_b64_tr_b16 a[144:145], v25 offset:24576
    ds_read_b64_tr_b16 a[146:147], v25 offset:25600
    ds_read_b64_tr_b16 a[148:149], v26 offset:24576
    ds_read_b64_tr_b16 a[150:151], v26 offset:25600
    v_mfma_f32_32x32x16_bf16 v[80:95], v[60:63], a[252:255], v[80:95]
    s_waitcnt vmcnt(8)
    s_add_u32 s54, s51, 2
    v_mov_b32 v34, s54
    v_mov_b32 v35, s52
    v_mov_b32 v36, 0
    s_mov_b64 exec, 1
    buffer_store_dwordx2 v[34:35], v36, s[20:23], s50 offen sc1
    s_mov_b64 exec, -1
    s_nop 3
    s_waitcnt vmcnt(6)
    s_add_u32 s54, s51, 1
    v_subrev_u32 v34, s54, v30
    v_cmp_eq_u32 s[66:67], s52, v31
    v_cmp_ge_u32 vcc, 2, v34
    s_nop 1
    s_and_b64 vcc, vcc, s[66:67]
    s_cmp_eq_u64 vcc, -1
    s_cbranch_scc0 H_slow_3
    v_pk_mul_f32 v[240:241], v[64:65], s[68:69]
    v_pk_mul_f32 v[242:243], v[66:67], s[68:69]
    v_pk_mul_f32 v[244:245], v[68:69], s[68:69]
    v_pk_mul_f32 v[246:247], v[70:71], s[68:69]
    v_exp_f32 v240, v240
    v_exp_f32 v242, v242
    v_exp_f32 v244, v244
    v_exp_f32 v246, v246
    v_exp_f32 v241, v241
    v_exp_f32 v243, v243
    buffer_load_dwordx4 v[192:195], v27, s[20:23], s4 offen sc1
    v_exp_f32 v245, v245
    v_exp_f32 v247, v247
    v_pk_fma_f32 v[240:241], v[240:241], v[28:29], v[28:29] op_sel_hi:[1,0,0]
    v_pk_fma_f32 v[242:243], v[242:243], v[28:29], v[28:29] op_sel_hi:[1,0,0]
    v_pk_fma_f32 v[244:245], v[244:245], v[28:29], v[28:29] op_sel_hi:[1,0,0]
    v_pk_fma_f32 v[246:247], v[246:247], v[28:29], v[28:29] op_sel_hi:[1,0,0]
    v_rcp_f32 v240, v240
    v_rcp_f32 v242, v242
    v_rcp_f32 v244, v244
    v_rcp_f32 v246, v246
    buffer_load_dwordx4 v[196:199], v27, s[20:23], s4 offen offset:1024 sc1
    v_rcp_f32 v241, v241
    v_rcp_f32 v243, v243
    v_rcp_f32 v245, v245
    v_rcp_f32 v247, v247
    v_pk_mul_f32 v[240:241], v[64:65], v[240:241]
    v_pk_mul_f32 v[242:243], v[66:67], v[242:243]
    v_pk_mul_f32 v[244:245], v[68:69], v[244:245]
    v_pk_mul_f32 v[246:247], v[70:71], v[246:247]
    v_cvt_pk_bf16_f32 v160, v240, v241
    v_cvt_pk_bf16_f32 v161, v242, v243
    v_cvt_pk_bf16_f32 v162, v244, v245
    buffer_load_dwordx4 v[200:203], v27, s[20:23], s4 offen offset:2048 sc1
    v_cvt_pk_bf16_f32 v163, v246, v247
    s_add_u32 s55, s48, s35
    buffer_store_dwordx4 v[160:163], v27, s[20:23], s55 offen sc1
    v_pk_mul_f32 v[240:241], v[72:73], s[68:69]
    v_pk_mul_f32 v[242:243], v[74:75], s[68:69]
    v_pk_mul_f32 v[244:245], v[76:77], s[68:69]
    v_pk_mul_f32 v[246:247], v[78:79], s[68:69]
    v_exp_f32 v240, v240
    v_exp_f32 v242, v242
    v_exp_f32 v244, v244
    v_exp_f32 v246, v246
    v_exp_f32 v241, v241
    v_exp_f32 v243, v243
    buffer_load_dwordx4 v[204:207], v27, s[20:23], s4 offen offset:3072 sc1
    v_exp_f32 v245, v245
    v_exp_f32 v247, v247
    v_pk_fma_f32 v[240:241], v[240:241], v[28:29], v[28:29] op_sel_hi:[1,0,0]
    v_pk_fma_f32 v[242:243], v[242:243], v[28:29], v[28:29] op_sel_hi:[1,0,0]
    v_pk_fma_f32 v[244:245], v[244:245], v[28:29], v[28:29] op_sel_hi:[1,0,0]
    v_pk_fma_f32 v[246:247], v[246:247], v[28:29], v[28:29] op_sel_hi:[1,0,0]
    v_rcp_f32 v240, v240
    v_rcp_f32 v242, v242
    v_rcp_f32 v244, v244
    v_rcp_f32 v246, v246
    buffer_load_dwordx4 v[208:211], v27, s[20:23], s5 offen sc1
    v_rcp_f32 v241, v241
    v_rcp_f32 v243, v243
    v_rcp_f32 v245, v245
    v_rcp_f32 v247, v247
    v_pk_mul_f32 v[240:241], v[72:73], v[240:241]
    v_pk_mul_f32 v[242:243], v[74:75], v[242:243]
    v_pk_mul_f32 v[244:245], v[76:77], v[244:245]
    v_pk_mul_f32 v[246:247], v[78:79], v[246:247]
    v_cvt_pk_bf16_f32 v164, v240, v241
    v_cvt_pk_bf16_f32 v165, v242, v243
    v_cvt_pk_bf16_f32 v166, v244, v245
    buffer_load_dwordx4 v[212:215], v27, s[20:23], s5 offen offset:1024 sc1
    v_cvt_pk_bf16_f32 v167, v246, v247
    s_add_u32 s55, s48, s35
    buffer_store_dwordx4 v[164:167], v27, s[20:23], s55 offen offset:2048 sc1
    v_pk_mul_f32 v[240:241], v[80:81], s[68:69]
    v_pk_mul_f32 v[242:243], v[82:83], s[68:69]
    v_pk_mul_f32 v[244:245], v[84:85], s[68:69]
    v_pk_mul_f32 v[246:247], v[86:87], s[68:69]
    v_exp_f32 v240, v240
    v_exp_f32 v242, v242
    v_exp_f32 v244, v244
    v_exp_f32 v246, v246
    v_exp_f32 v241, v241
    v_exp_f32 v243, v243
    buffer_load_dwordx4 v[216:219], v27, s[20:23], s5 offen offset:2048 sc1
    v_exp_f32 v245, v245
    v_exp_f32 v247, v247
    v_pk_fma_f32 v[240:241], v[240:241], v[28:29], v[28:29] op_sel:[0,1,1] op_sel_hi:[1,1,1]
    v_pk_fma_f32 v[242:243], v[242:243], v[28:29], v[28:29] op_sel:[0,1,1] op_sel_hi:[1,1,1]
    v_pk_fma_f32 v[244:245], v[244:245], v[28:29], v[28:29] op_sel:[0,1,1] op_sel_hi:[1,1,1]
    v_pk_fma_f32 v[246:247], v[246:247], v[28:29], v[28:29] op_sel:[0,1,1] op_sel_hi:[1,1,1]
    v_rcp_f32 v240, v240
    v_rcp_f32 v242, v242
    v_rcp_f32 v244, v244
    v_rcp_f32 v246, v246
    buffer_load_dwordx4 v[220:223], v27, s[20:23], s5 offen offset:3072 sc1
    v_rcp_f32 v241, v241
    v_rcp_f32 v243, v243
    v_rcp_f32 v245, v245
    v_rcp_f32 v247, v247
    v_pk_mul_f32 v[240:241], v[80:81], v[240:241]
    v_pk_mul_f32 v[242:243], v[82:83], v[242:243]
    v_pk_mul_f32 v[244:245], v[84:85], v[244:245]
    v_pk_mul_f32 v[246:247], v[86:87], v[246:247]
    v_cvt_pk_bf16_f32 v168, v240, v241
    v_cvt_pk_bf16_f32 v169, v242, v243
    v_cvt_pk_bf16_f32 v170, v244, v245
    buffer_load_dwordx4 v[224:227], v27, s[20:23], s6 offen sc1
    v_cvt_pk_bf16_f32 v171, v246, v247
    s_add_u32 s55, s49, s35
    buffer_store_dwordx4 v[168:171], v27, s[20:23], s55 offen sc1
    v_pk_mul_f32 v[240:241], v[88:89], s[68:69]
    v_pk_mul_f32 v[242:243], v[90:91], s[68:69]
    v_pk_mul_f32 v[244:245], v[92:93], s[68:69]
    v_pk_mul_f32 v[246:247], v[94:95], s[68:69]
    v_exp_f32 v240, v240
    v_exp_f32 v242, v242
    v_exp_f32 v244, v244
    v_exp_f32 v246, v246
    v_exp_f32 v241, v241
    v_exp_f32 v243, v243
    buffer_load_dwordx4 v[228:231], v27, s[20:23], s6 offen offset:1024 sc1
    v_exp_f32 v245, v245
    v_exp_f32 v247, v247
    v_pk_fma_f32 v[240:241], v[240:241], v[28:29], v[28:29] op_sel:[0,1,1] op_sel_hi:[1,1,1]
    v_pk_fma_f32 v[242:243], v[242:243], v[28:29], v[28:29] op_sel:[0,1,1] op_sel_hi:[1,1,1]
    v_pk_fma_f32 v[244:245], v[244:245], v[28:29], v[28:29] op_sel:[0,1,1] op_sel_hi:[1,1,1]
    v_pk_fma_f32 v[246:247], v[246:247], v[28:29], v[28:29] op_sel:[0,1,1] op_sel_hi:[1,1,1]
    v_rcp_f32 v240, v240
    v_rcp_f32 v242, v242
    v_rcp_f32 v244, v244
    v_rcp_f32 v246, v246
    buffer_load_dwordx4 v[232:235], v27, s[20:23], s6 offen offset:2048 sc1
    v_rcp_f32 v241, v241
    v_rcp_f32 v243, v243
    v_rcp_f32 v245, v245
    v_rcp_f32 v247, v247
    v_pk_mul_f32 v[240:241], v[88:89], v[240:241]
    v_pk_mul_f32 v[242:243], v[90:91], v[242:243]
    v_pk_mul_f32 v[244:245], v[92:93], v[244:245]
    v_pk_mul_f32 v[246:247], v[94:95], v[246:247]
    v_cvt_pk_bf16_f32 v172, v240, v241
    v_cvt_pk_bf16_f32 v173, v242, v243
    v_cvt_pk_bf16_f32 v174, v244, v245
    buffer_load_dwordx4 v[236:239], v27, s[20:23], s6 offen offset:3072 sc1
    v_cvt_pk_bf16_f32 v175, v246, v247
    s_add_u32 s55, s49, s35
    buffer_store_dwordx4 v[172:175], v27, s[20:23], s55 offen offset:2048 sc1
H_join_4:
    buffer_load_dwordx2 v[30:31], v32, s[20:23], 0 offen offset:32 sc1
    s_barrier
    s_waitcnt vmcnt(15)
    v_mfma_f32_32x32x16_bf16 v[64:79], a[0:3], v[192:195], 0
    buffer_load_dwordx4 v[240:243], v27, s[20:23], s7 offen sc1
    v_mfma_f32_32x32x16_bf16 v[96:111], a[4:7], v[192:195], 0
    s_add_u32 m0, s36, 32768
    s_lshl3_add_u32 s53, s78, s43
    buffer_load_dwordx4 v10, s[16:19], s53 offen lds
    v_mfma_f32_32x32x16_bf16 v[80:95], a[0:3], v[196:199], 0
    buffer_load_dwordx4 v[244:247], v27, s[20:23], s7 offen offset:1024 sc1
    v_mfma_f32_32x32x16_bf16 v[112:127], a[4:7], v[196:199], 0
    ds_read_b64_tr_b16 a[152:153], v25 offset:26624
    ds_read_b64_tr_b16 a[154:155], v25 offset:27648
    ds_read_b64_tr_b16 a[156:157], v26 offset:26624
    ds_read_b64_tr_b16 a[158:159], v26 offset:27648
    s_waitcnt vmcnt(15)
    v_mfma_f32_32x32x16_bf16 v[64:79], a[8:11], v[200:203], v[64:79]
    buffer_load_dwordx4 v[248:251], v27, s[20:23], s7 offen offset:2048 sc1
    v_mfma_f32_32x32x16_bf16 v[96:111], a[12:15], v[200:203], v[96:111]
    buffer_load_dwordx4 v11, s[16:19], s53 offen offset:1024 lds
    v_mfma_f32_32x32x16_bf16 v[80:95], a[8:11], v[204:207], v[80:95]
    buffer_load_dwordx4 v[252:255], v27, s[20:23], s7 offen offset:3072 sc1
    v_mfma_f32_32x32x16_bf16 v[112:127], a[12:15], v[204:207], v[112:127]
    ds_read_b64_tr_b16 a[160:161], v25 offset:20480
    ds_read_b64_tr_b16 a[162:163], v25 offset:21504
    ds_read_b64_tr_b16 a[164:165], v26 offset:20480
    ds_read_b64_tr_b16 a[166:167], v26 offset:21504
    s_waitcnt vmcnt(7)
    s_add_u32 s54, s51, 3
    v_mov_b32 v34, s54
    v_mov_b32 v35, s52
    v_mov_b32 v36, 0
    s_mov_b64 exec, 1
    buffer_store_dwordx2 v[34:35], v36, s[20:23], s50 offen sc1
    s_mov_b64 exec, -1
    v_mfma_f32_32x32x16_bf16 v[64:79], a[16:19], v[208:211], v[64:79]
    buffer_load_dwordx4 v2, s[16:19], s53 offen offset:2048 lds
    v_mfma_f32_32x32x16_bf16 v[96:111], a[20:23], v[208:211], v[96:111]
    buffer_load_dwordx4 v3, s[16:19], s53 offen offset:3072 lds
    v_mfma_f32_32x32x16_bf16 v[80:95], a[16:19], v[212:215], v[80:95]
    s_add_u32 m0, s36, 12288
    s_lshl3_add_u32 s53, s61, s43
    buffer_load_dwordx4 v10, s[16:19], s53 offen lds
    v_mfma_f32_32x32x16_bf16 v[112:127], a[20:23], v[212:215], v[112:127]
    ds_read_b64_tr_b16 a[168:169], v25 offset:22528
    ds_read_b64_tr_b16 a[170:171], v25 offset:23552
    ds_read_b64_tr_b16 a[172:173], v26 offset:22528
    ds_read_b64_tr_b16 a[174:175], v26 offset:23552
    v_mfma_f32_32x32x16_bf16 v[64:79], a[24:27], v[216:219], v[64:79]
    s_waitcnt vmcnt(10)
H_pc_5:
    s_add_u32 s54, s51, 2
    v_subrev_u32 v34, s54, v30
    v_cmp_eq_u32 s[66:67], s52, v31
    v_cmp_ge_u32 vcc, 1, v34
    s_nop 1
    s_and_b64 vcc, vcc, s[66:67]
    s_cmp_eq_u64 vcc, -1
    s_cbranch_scc1 H_pok_6
    s_add_u32 s63, s63, 1
    s_cmp_lt_u32 s63, 0x40000
    s_cbranch_scc0 L_end
    s_sleep 1
    buffer_load_dwordx2 v[30:31], v32, s[20:23], 0 offen offset:32 sc1
    s_waitcnt vmcnt(0)
    s_branch H_pc_5
H_pok_6:
    s_add_u32 s39, s4, 8192
    buffer_load_dwordx4 v[192:195], v27, s[20:23], s39 offen sc1
    v_mfma_f32_32x32x16_bf16 v[96:111], a[28:31], v[216:219], v[96:111]
    buffer_load_dwordx4 v11, s[16:19], s53 offen offset:1024 lds
    v_mfma_f32_32x32x16_bf16 v[80:95], a[24:27], v[220:223], v[80:95]
    buffer_load_dwordx4 v[196:199], v27, s[20:23], s39 offen offset:1024 sc1
    v_mfma_f32_32x32x16_bf16 v[112:127], a[28:31], v[220:223], v[112:127]
    ds_read_b64_tr_b16 a[176:177], v25 offset:16384
    ds_read_b64_tr_b16 a[178:179], v25 offset:17408
    ds_read_b64_tr_b16 a[180:181], v26 offset:16384
    ds_read_b64_tr_b16 a[182:183], v26 offset:17408
    v_mfma_f32_32x32x16_bf16 v[64:79], a[32:35], v[224:227], v[64:79]
    s_add_u32 s39, s4, 8192
    buffer_load_dwordx4 v[200:203], v27, s[20:23], s39 offen offset:2048 sc1
    v_mfma_f32_32x32x16_bf16 v[96:111], a[36:39], v[224:227], v[96:111]
    buffer_load_dwordx4 v2, s[16:19], s53 offen offset:2048 lds
    v_mfma_f32_32x32x16_bf16 v[80:95], a[32:35], v[228:231], v[80:95]
    buffer_load_dwordx4 v[204:207], v27, s[20:23], s39 offen offset:3072 sc1
    v_mfma_f32_32x32x16_bf16 v[112:127], a[36:39], v[228:231], v[112:127]
    ds_read_b64_tr_b16 a[184:185], v25 offset:18432
    ds_read_b64_tr_b16 a[186:187], v25 offset:19456
    ds_read_b64_tr_b16 a[188:189], v26 offset:18432
    ds_read_b64_tr_b16 a[190:191], v26 offset:19456
    v_mfma_f32_32x32x16_bf16 v[64:79], a[40:43], v[232:235], v[64:79]
    s_add_u32 s39, s5, 8192
    buffer_load_dwordx4 v[208:211], v27, s[20:23], s39 offen sc1
    v_mfma_f32_32x32x16_bf16 v[96:111], a[44:47], v[232:235], v[96:111]
    buffer_load_dwordx4 v3, s[16:19], s53 offen offset:3072 lds
    v_mfma_f32_32x32x16_bf16 v[80:95], a[40:43], v[236:239], v[80:95]
    buffer_load_dwordx4 v[212:215], v27, s[20:23], s39 offen offset:1024 sc1
    v_mfma_f32_32x32x16_bf16 v[112:127], a[44:47], v[236:239], v[112:127]
    buffer_load_dwordx2 v[30:31], v32, s[20:23], 0 offen offset:32 sc1
    s_waitcnt vmcnt(17)
    v_mfma_f32_32x32x16_bf16 v[64:79], a[48:51], v[240:243], v[64:79]
    s_add_u32 s39, s5, 8192
    buffer_load_dwordx4 v[216:219], v27, s[20:23], s39 offen offset:2048 sc1
    v_mfma_f32_32x32x16_bf16 v[96:111], a[52:55], v[240:243], v[96:111]
    ds_read_b64_tr_b16 a[192:193], v25 offset:36864
    ds_read_b64_tr_b16 a[194:195], v25 offset:37888
    ds_read_b64_tr_b16 a[196:197], v26 offset:36864
    ds_read_b64_tr_b16 a[198:199], v26 offset:37888
    v_mfma_f32_32x32x16_bf16 v[80:95], a[48:51], v[244:247], v[80:95]
    buffer_load_dwordx4 v[220:223], v27, s[20:23], s39 offen offset:3072 sc1
    v_mfma_f32_32x32x16_bf16 v[112:127], a[52:55], v[244:247], v[112:127]
    ds_read_b64_tr_b16 a[200:201], v25 offset:38912
    ds_read_b64_tr_b16 a[202:203], v25 offset:39936
    ds_read_b64_tr_b16 a[204:205], v26 offset:38912
    ds_read_b64_tr_b16 a[206:207], v26 offset:39936
    s_waitcnt vmcnt(16)
    v_mfma_f32_32x32x16_bf16 v[64:79], a[56:59], v[248:251], v[64:79]
    s_add_u32 s39, s6, 8192
    buffer_load_dwordx4 v[224:227], v27, s[20:23], s39 offen sc1
    v_mfma_f32_32x32x16_bf16 v[96:111], a[60:63], v[248:251], v[96:111]
    ds_read_b64_tr_b16 a[208:209], v25 offset:32768
    ds_read_b64_tr_b16 a[210:211], v25 offset:33792
    ds_read_b64_tr_b16 a[212:213], v26 offset:32768
    ds_read_b64_tr_b16 a[214:215], v26 offset:33792
    v_mfma_f32_32x32x16_bf16 v[80:95], a[56:59], v[252:255], v[80:95]
    buffer_load_dwordx4 v[228:231], v27, s[20:23], s39 offen offset:1024 sc1
    v_mfma_f32_32x32x16_bf16 v[112:127], a[60:63], v[252:255], v[112:127]
    s_waitcnt vmcnt(11)
    v_mfma_f32_32x32x16_bf16 v[64:79], a[64:67], v[192:195], v[64:79]
    s_add_u32 s39, s6, 8192
    buffer_load_dwordx4 v[232:235], v27, s[20:23], s39 offen offset:2048 sc1
    v_mfma_f32_32x32x16_bf16 v[96:111], a[68:71], v[192:195], v[96:111]
    ds_read_b64_tr_b16 a[216:217], v25 offset:34816
    ds_read_b64_tr_b16 a[218:219], v25 offset:35840
    ds_read_b64_tr_b16 a[220:221], v26 offset:34816
    ds_read_b64_tr_b16 a[222:223], v26 offset:35840
    v_mfma_f32_32x32x16_bf16 v[80:95], a[64:67], v[196:199], v[80:95]
    buffer_load_dwordx4 v[236:239], v27, s[20:23], s39 offen offset:3072 sc1
    v_mfma_f32_32x32x16_bf16 v[112:127], a[68:71], v[196:199], v[112:127]
    ds_read_b64_tr_b16 a[224:225], v25 offset:12288
    ds_read_b64_tr_b16 a[226:227], v25 offset:13312
    ds_read_b64_tr_b16 a[228:229], v26 offset:12288
    ds_read_b64_tr_b16 a[230:231], v26 offset:13312
    s_waitcnt vmcnt(10)
    v_mfma_f32_32x32x16_bf16 v[64:79], a[72:75], v[200:203], v[64:79]
    s_add_u32 s39, s7, 8192
    buffer_load_dwordx4 v[240:243], v27, s[20:23], s39 offen sc1
    v_mfma_f32_32x32x16_bf16 v[96:111], a[76:79], v[200:203], v[96:111]
    v_mfma_f32_32x32x16_bf16 v[80:95], a[72:75], v[204:207], v[80:95]
    buffer_load_dwordx4 v[244:247], v27, s[20:23], s39 offen offset:1024 sc1
    v_mfma_f32_32x32x16_bf16 v[112:127], a[76:79], v[204:207], v[112:127]
    s_waitcnt vmcnt(9)
    v_mfma_f32_32x32x16_bf16 v[64:79], a[80:83], v[208:211], v[64:79]
    s_add_u32 s39, s7, 8192
    buffer_load_dwordx4 v[248:251], v27, s[20:23], s39 offen offset:2048 sc1
    v_mfma_f32_32x32x16_bf16 v[96:111], a[84:87], v[208:211], v[96:111]
    ds_read_b64_tr_b16 a[232:233], v25 offset:14336
    ds_read_b64_tr_b16 a[234:235], v25 offset:15360
    ds_read_b64_tr_b16 a[236:237], v26 offset:14336
    ds_read_b64_tr_b16 a[238:239], v26 offset:15360
    v_mfma_f32_32x32x16_bf16 v[80:95], a[80:83], v[212:215], v[80:95]
    buffer_load_dwordx4 v[252:255], v27, s[20:23], s39 offen offset:3072 sc1
    v_mfma_f32_32x32x16_bf16 v[112:127], a[84:87], v[212:215], v[112:127]
    s_waitcnt vmcnt(8)
    v_mfma_f32_32x32x16_bf16 v[64:79], a[88:91], v[216:219], v[64:79]
H_pc_7:
    s_add_u32 s54, s51, 3
    v_subrev_u32 v34, s54, v30
    v_cmp_eq_u32 s[66:67], s52, v31
    v_cmp_ge_u32 vcc, 0, v34
    s_nop 1
    s_and_b64 vcc, vcc, s[66:67]
    s_cmp_eq_u64 vcc, -1
    s_cbranch_scc1 H_pok_8
    s_add_u32 s63, s63, 1
    s_cmp_lt_u32 s63, 0x40000
    s_cbranch_scc0 L_end
    s_sleep 1
    buffer_load_dwordx2 v[30:31], v32, s[20:23], 0 offen offset:32 sc1
    s_waitcnt vmcnt(0)
    s_branch H_pc_7
H_pok_8:
    s_add_u32 s39, s44, 16384
    buffer_load_dwordx4 v[192:195], v27, s[20:23], s39 offen sc1
    v_mfma_f32_32x32x16_bf16 v[96:111], a[92:95], v[216:219], v[96:111]
    v_mfma_f32_32x32x16_bf16 v[80:95], a[88:91], v[220:223], v[80:95]
    buffer_load_dwordx4 v[196:199], v27, s[20:23], s39 offen offset:1024 sc1
    v_mfma_f32_32x32x16_bf16 v[112:127], a[92:95], v[220:223], v[112:127]
    s_waitcnt vmcnt(8)
    v_mfma_f32_32x32x16_bf16 v[64:79], a[96:99], v[224:227], v[64:79]
    s_add_u32 s39, s44, 16384
    buffer_load_dwordx4 v[200:203], v27, s[20:23], s39 offen offset:2048 sc1
    v_mfma_f32_32x32x16_bf16 v[96:111], a[100:103], v[224:227], v[96:111]
    buffer_load_dwordx2 v[30:31], v32, s[20:23], 0 offen sc1
    v_mfma_f32_32x32x16_bf16 v[80:95], a[96:99], v[228:231], v[80:95]
    buffer_load_dwordx4 v[204:207], v27, s[20:23], s39 offen offset:3072 sc1
    v_mfma_f32_32x32x16_bf16 v[112:127], a[100:103], v[228:231], v[112:127]
    s_waitcnt vmcnt(9)
    v_mfma_f32_32x32x16_bf16 v[64:79], a[104:107], v[232:235], v[64:79]
    s_add_u32 s39, s45, 16384
    buffer_load_dwordx4 v[208:211], v27, s[20:23], s39 offen sc1
    v_mfma_f32_32x32x16_bf16 v[96:111], a[108:111], v[232:235], v[96:111]
    v_mfma_f32_32x32x16_bf16 v[80:95], a[104:107], v[236:239], v[80:95]
    buffer_load_dwordx4 v[212:215], v27, s[20:23], s39 offen offset:1024 sc1
    v_mfma_f32_32x32x16_bf16 v[112:127], a[108:111], v[236:239], v[112:127]
    s_waitcnt vmcnt(9)
    v_mfma_f32_32x32x16_bf16 v[64:79], a[112:115], v[240:243], v[64:79]
    s_add_u32 s39, s45, 16384
    buffer_load_dwordx4 v[216:219], v27, s[20:23], s39 offen offset:2048 sc1
    v_mfma_f32_32x32x16_bf16 v[96:111], a[116:119], v[240:243], v[96:111]
    v_mfma_f32_32x32x16_bf16 v[80:95], a[112:115], v[244:247], v[80:95]
    buffer_load_dwordx4 v[220:223], v27, s[20:23], s39 offen offset:3072 sc1
    v_mfma_f32_32x32x16_bf16 v[112:127], a[116:119], v[244:247], v[112:127]
    s_waitcnt vmcnt(9)
    v_mfma_f32_32x32x16_bf16 v[64:79], a[120:123], v[248:251], v[64:79]
    buffer_load_dwordx4 v[224:227], v27, s[20:23], s46 offen sc1
    v_mfma_f32_32x32x16_bf16 v[96:111], a[124:127], v[248:251], v[96:111]
    v_mfma_f32_32x32x16_bf16 v[80:95], a[120:123], v[252:255], v[80:95]
    buffer_load_dwordx4 v[228:231], v27, s[20:23], s46 offen offset:1024 sc1
    v_mfma_f32_32x32x16_bf16 v[112:127], a[124:127], v[252:255], v[112:127]
    s_waitcnt vmcnt(9)
    v_mfma_f32_32x32x16_bf16 v[64:79], a[128:131], v[192:195], v[64:79]
    buffer_load_dwordx4 v[232:235], v27, s[20:23], s46 offen offset:2048 sc1
    v_mfma_f32_32x32x16_bf16 v[96:111], a[132:135], v[192:195], v[96:111]
    v_mfma_f32_32x32x16_bf16 v[80:95], a[128:131], v[196:199], v[80:95]
    buffer_load_dwordx4 v[236:239], v27, s[20:23], s46 offen offset:3072 sc1
    v_mfma_f32_32x32x16_bf16 v[112:127], a[132:135], v[196:199], v[112:127]
    s_waitcnt vmcnt(8) lgkmcnt(14)
    v_mfma_f32_32x32x16_bf16 v[64:79], a[136:139], v[200:203], v[64:79]
H_pc_9:
    s_add_u32 s54, s51, 1
    v_subrev_u32 v34, s54, v30
    v_cmp_eq_u32 s[66:67], s52, v31
    v_cmp_ge_u32 vcc, 2, v34
    s_nop 1
    s_and_b64 vcc, vcc, s[66:67]
    s_cmp_eq_u64 vcc, -1
    s_cbranch_scc1 H_pok_10
    s_add_u32 s63, s63, 1
    s_cmp_lt_u32 s63, 0x40000
    s_cbranch_scc0 L_end
    s_sleep 1
    buffer_load_dwordx2 v[30:31], v32, s[20:23], 0 offen sc1
    s_waitcnt vmcnt(0)
    s_branch H_pc_9
H_pok_10:
    s_add_u32 s39, s73, s47
    buffer_load_dwordx4 v[240:243], v27, s[20:23], s39 offen sc1
    v_mfma_f32_32x32x16_bf16 v[96:111], a[140:143], v[200:203], v[96:111]
    v_mfma_f32_32x32x16_bf16 v[80:95], a[136:139], v[204:207], v[80:95]
    buffer_load_dwordx4 v[244:247], v27, s[20:23], s39 offen offset:1024 sc1
    v_mfma_f32_32x32x16_bf16 v[112:127], a[140:143], v[204:207], v[112:127]
    s_waitcnt vmcnt(8)
    v_mfma_f32_32x32x16_bf16 v[64:79], a[144:147], v[208:211], v[64:79]
    s_add_u32 s39, s73, s47
    buffer_load_dwordx4 v[248:251], v27, s[20:23], s39 offen offset:2048 sc1
    v_mfma_f32_32x32x16_bf16 v[96:111], a[148:151], v[208:211], v[96:111]
    v_mfma_f32_32x32x16_bf16 v[80:95], a[144:147], v[212:215], v[80:95]
    buffer_load_dwordx4 v[252:255], v27, s[20:23], s39 offen offset:3072 sc1
    v_mfma_f32_32x32x16_bf16 v[112:127], a[148:151], v[212:215], v[112:127]
    s_waitcnt vmcnt(8)
    v_mfma_f32_32x32x16_bf16 v[64:79], a[152:155], v[216:219], v[64:79]
    s_add_u32 s39, s74, s47
    buffer_load_dwordx4 v[192:195], v27, s[20:23], s39 offen sc1
    v_mfma_f32_32x32x16_bf16 v[96:111], a[156:159], v[216:219], v[96:111]
    v_mfma_f32_32x32x16_bf16 v[80:95], a[152:155], v[220:223], v[80:95]
    buffer_load_dwordx4 v[196:199], v27, s[20:23], s39 offen offset:1024 sc1
    v_mfma_f32_32x32x16_bf16 v[112:127], a[156:159], v[220:223], v[112:127]
    s_waitcnt vmcnt(8)
    v_mfma_f32_32x32x16_bf16 v[64:79], a[160:163], v[224:227], v[64:79]
    s_add_u32 s39, s74, s47
    buffer_load_dwordx4 v[200:203], v27, s[20:23], s39 offen offset:2048 sc1
    v_mfma_f32_32x32x16_bf16 v[96:111], a[164:167], v[224:227], v[96:111]
    v_mfma_f32_32x32x16_bf16 v[80:95], a[160:163], v[228:231], v[80:95]
    buffer_load_dwordx4 v[204:207], v27, s[20:23], s39 offen offset:3072 sc1
    v_mfma_f32_32x32x16_bf16 v[112:127], a[164:167], v[228:231], v[112:127]
    s_waitcnt vmcnt(8)
    v_mfma_f32_32x32x16_bf16 v[64:79], a[168:171], v[232:235], v[64:79]
    s_add_u32 s39, s78, s47
    buffer_load_dwordx4 v[208:211], v27, s[20:23], s39 offen sc1
    v_mfma_f32_32x32x16_bf16 v[96:111], a[172:175], v[232:235], v[96:111]
    v_mfma_f32_32x32x16_bf16 v[80:95], a[168:171], v[236:239], v[80:95]
    buffer_load_dwordx4 v[212:215], v27, s[20:23], s39 offen offset:1024 sc1
    v_mfma_f32_32x32x16_bf16 v[112:127], a[172:175], v[236:239], v[112:127]
    s_waitcnt vmcnt(8)
    v_mfma_f32_32x32x16_bf16 v[64:79], a[176:179], v[240:243], v[64:79]
    s_add_u32 s39, s78, s47
    buffer_load_dwordx4 v[216:219], v27, s[20:23], s39 offen offset:2048 sc1
    v_mfma_f32_32x32x16_bf16 v[96:111], a[180:183], v[240:243], v[96:111]
    v_mfma_f32_32x32x16_bf16 v[80:95], a[176:179], v[244:247], v[80:95]
    buffer_load_dwordx4 v[220:223], v27, s[20:23], s39 offen offset:3072 sc1
    v_mfma_f32_32x32x16_bf16 v[112:127], a[180:183], v[244:247], v[112:127]
    s_waitcnt vmcnt(8)
    v_mfma_f32_32x32x16_bf16 v[64:79], a[184:187], v[248:251], v[64:79]
    s_add_u32 s39, s61, s47
    buffer_load_dwordx4 v[224:227], v27, s[20:23], s39 offen sc1
    v_mfma_f32_32x32x16_bf16 v[96:111], a[188:191], v[248:251], v[96:111]
    v_mfma_f32_32x32x16_bf16 v[80:95], a[184:187], v[252:255], v[80:95]
    buffer_load_dwordx4 v[228:231], v27, s[20:23], s39 offen offset:1024 sc1
    v_mfma_f32_32x32x16_bf16 v[112:127], a[188:191], v[252:255], v[112:127]
    s_waitcnt vmcnt(8)
    v_mfma_f32_32x32x16_bf16 v[64:79], a[192:195], v[192:195], v[64:79]
    s_add_u32 s39, s61, s47
    buffer_load_dwordx4 v[232:235], v27, s[20:23], s39 offen offset:2048 sc1
    v_mfma_f32_32x32x16_bf16 v[96:111], a[196:199], v[192:195], v[96:111]
    v_mfma_f32_32x32x16_bf16 v[80:95], a[192:195], v[196:199], v[80:95]
    buffer_load_dwordx4 v[236:239], v27, s[20:23], s39 offen offset:3072 sc1
    v_mfma_f32_32x32x16_bf16 v[112:127], a[196:199], v[196:199], v[112:127]
    s_waitcnt vmcnt(8)
    v_mfma_f32_32x32x16_bf16 v[64:79], a[200:203], v[200:203], v[64:79]
    v_mfma_f32_32x32x16_bf16 v[96:111], a[204:207], v[200:203], v[96:111]
    v_mfma_f32_32x32x16_bf16 v[80:95], a[200:203], v[204:207], v[80:95]
    v_mfma_f32_32x32x16_bf16 v[112:127], a[204:207], v[204:207], v[112:127]
    s_waitcnt vmcnt(6) lgkmcnt(12)
    v_mfma_f32_32x32x16_bf16 v[64:79], a[208:211], v[208:211], v[64:79]
    v_and_b32 v21, 31, v1
    v_lshrrev_b32 v22, 5, v1
    v_mul_u32_u24 v21, 272, v21
    v_lshl_add_u32 v21, v22, 4, v21
    v_add_u32 v21, s36, v21
    v_mfma_f32_32x32x16_bf16 v[96:111], a[212:215], v[208:211], v[96:111]
    v_bfe_u32 v22, v1, 2, 3
    v_bcnt_u32_b32 v23, v22, 0
    v_and_b32 v23, 1, v23
    v_lshrrev_b32 v22, 2, v22
    v_lshl_add_u32 v22, v23, 1, v22
    v_mfma_f32_32x32x16_bf16 v[80:95], a[208:211], v[212:215], v[80:95]
    v_lshrrev_b32 v23, 5, v1
    v_lshl_add_u32 v22, v23, 2, v22
    v_bfe_u32 v23, v1, 3, 1
    v_and_b32 v24, 3, v1
    v_lshl_add_u32 v23, v23, 2, v24
    v_mfma_f32_32x32x16_bf16 v[112:127], a[212:215], v[212:215], v[112:127]
    v_lshlrev_b32 v24, 10, v22
    v_lshl_add_u32 v24, v23, 4, v24
    v_mul_u32_u24 v22, 272, v22
    v_lshl_add_u32 v22, v23, 5, v22
    s_mul_i32 s50, s3, 4352
    s_waitcnt vmcnt(4) lgkmcnt(8)
    v_mfma_f32_32x32x16_bf16 v[64:79], a[216:219], v[216:219], v[64:79]
    v_add_u32 v22, s50, v22
    v_add_u32 v23, 81920, v22
    s_add_u32 s50, s32, 8192
    v_mfma_f32_32x32x16_bf16 v[96:111], a[220:223], v[216:219], v[96:111]
    v_mfma_f32_32x32x16_bf16 v[80:95], a[216:219], v[220:223], v[80:95]
    v_mfma_f32_32x32x16_bf16 v[112:127], a[220:223], v[220:223], v[112:127]
    s_waitcnt vmcnt(2) lgkmcnt(4)
    v_mfma_f32_32x32x16_bf16 v[64:79], a[224:227], v[224:227], v[64:79]
    v_mfma_f32_32x32x16_bf16 v[96:111], a[228:231], v[224:227], v[96:111]
    v_mfma_f32_32x32x16_bf16 v[80:95], a[224:227], v[228:231], v[80:95]
    v_mfma_f32_32x32x16_bf16 v[112:127], a[228:231], v[228:231], v[112:127]
    s_waitcnt vmcnt(0) lgkmcnt(0)
    v_mfma_f32_32x32x16_bf16 v[64:79], a[232:235], v[232:235], v[64:79]
    v_mfma_f32_32x32x16_bf16 v[96:111], a[236:239], v[232:235], v[96:111]
    v_mfma_f32_32x32x16_bf16 v[80:95], a[232:235], v[236:239], v[80:95]
    v_mfma_f32_32x32x16_bf16 v[112:127], a[236:239], v[236:239], v[112:127]
    s_nop 8
    ds_write_b128 v21, v[64:67] offset:0
    ds_write_b128 v21, v[68:71] offset:32
    ds_write_b128 v21, v[72:75] offset:64
    ds_write_b128 v21, v[76:79] offset:96
    ds_write_b128 v21, v[96:99] offset:128
    ds_write_b128 v21, v[100:103] offset:160
    ds_write_b128 v21, v[104:107] offset:192
    ds_write_b128 v21, v[108:111] offset:224
    ds_write_b128 v21, v[80:83] offset:8704
    ds_write_b128 v21, v[84:87] offset:8736
    ds_write_b128 v21, v[88:91] offset:8768
    ds_write_b128 v21, v[92:95] offset:8800
    ds_write_b128 v21, v[112:115] offset:8832
    ds_write_b128 v21, v[116:119] offset:8864
    ds_write_b128 v21, v[120:123] offset:8896
    ds_write_b128 v21, v[124:127] offset:8928
    s_waitcnt lgkmcnt(0)
    s_barrier
    ds_read_b128 v[128:131], v22 offset:0
    ds_read_b128 v[132:135], v22 offset:16
    ds_read_b128 v[136:139], v22 offset:40960
    ds_read_b128 v[140:143], v22 offset:40976
    ds_read_b128 v[144:147], v23 offset:0
    ds_read_b128 v[148:151], v23 offset:16
    ds_read_b128 v[152:155], v23 offset:40960
    ds_read_b128 v[156:159], v23 offset:40976
    ds_read_b128 v[160:163], v22 offset:2176
    ds_read_b128 v[164:167], v22 offset:2192
    ds_read_b128 v[168:171], v22 offset:43136
    ds_read_b128 v[172:175], v22 offset:43152
    ds_read_b128 v[176:179], v23 offset:2176
    ds_read_b128 v[180:183], v23 offset:2192
    ds_read_b128 v[184:187], v23 offset:43136
    ds_read_b128 v[188:191], v23 offset:43152
    s_waitcnt lgkmcnt(8)
    v_pk_add_f32 v[128:129], v[128:129], v[136:137]
    v_pk_add_f32 v[144:145], v[144:145], v[152:153]
    v_pk_add_f32 v[130:131], v[130:131], v[138:139]
    v_pk_add_f32 v[146:147], v[146:147], v[154:155]
    v_pk_add_f32 v[132:133], v[132:133], v[140:141]
    v_pk_add_f32 v[148:149], v[148:149], v[156:157]
    v_pk_add_f32 v[134:135], v[134:135], v[142:143]
    v_pk_add_f32 v[150:151], v[150:151], v[158:159]
    v_pk_add_f32 v[128:129], v[128:129], v[144:145]
    v_pk_add_f32 v[130:131], v[130:131], v[146:147]
    v_pk_add_f32 v[132:133], v[132:133], v[148:149]
    v_pk_add_f32 v[134:135], v[134:135], v[150:151]
    v_cvt_pk_bf16_f32 v128, v128, v129
    v_cvt_pk_bf16_f32 v129, v130, v131
    v_cvt_pk_bf16_f32 v130, v132, v133
    v_cvt_pk_bf16_f32 v131, v134, v135
    buffer_store_dwordx4 v[128:131], v24, s[24:27], s32 offen
    s_waitcnt lgkmcnt(0)
    v_pk_add_f32 v[160:161], v[160:161], v[168:169]
    v_pk_add_f32 v[176:177], v[176:177], v[184:185]
    v_pk_add_f32 v[162:163], v[162:163], v[170:171]
    v_pk_add_f32 v[178:179], v[178:179], v[186:187]
    v_pk_add_f32 v[164:165], v[164:165], v[172:173]
    v_pk_add_f32 v[180:181], v[180:181], v[188:189]
    v_pk_add_f32 v[166:167], v[166:167], v[174:175]
    v_pk_add_f32 v[182:183], v[182:183], v[190:191]
    v_pk_add_f32 v[160:161], v[160:161], v[176:177]
    v_pk_add_f32 v[162:163], v[162:163], v[178:179]
    v_pk_add_f32 v[164:165], v[164:165], v[180:181]
    v_pk_add_f32 v[166:167], v[166:167], v[182:183]
    v_cvt_pk_bf16_f32 v160, v160, v161
    v_cvt_pk_bf16_f32 v161, v162, v163
    v_cvt_pk_bf16_f32 v162, v164, v165
    v_cvt_pk_bf16_f32 v163, v166, v167
    buffer_store_dwordx4 v[160:163], v24, s[24:27], s50 offen
    s_endpgm
H_slow_3:
    v_pk_mul_f32 v[240:241], v[64:65], s[68:69]
    v_pk_mul_f32 v[242:243], v[66:67], s[68:69]
    v_pk_mul_f32 v[244:245], v[68:69], s[68:69]
    v_pk_mul_f32 v[246:247], v[70:71], s[68:69]
    v_exp_f32 v240, v240
    v_exp_f32 v242, v242
    v_exp_f32 v244, v244
    v_exp_f32 v246, v246
    v_exp_f32 v241, v241
    v_exp_f32 v243, v243
    v_exp_f32 v245, v245
    v_exp_f32 v247, v247
    v_pk_fma_f32 v[240:241], v[240:241], v[28:29], v[28:29] op_sel_hi:[1,0,0]
    v_pk_fma_f32 v[242:243], v[242:243], v[28:29], v[28:29] op_sel_hi:[1,0,0]
    v_pk_fma_f32 v[244:245], v[244:245], v[28:29], v[28:29] op_sel_hi:[1,0,0]
    v_pk_fma_f32 v[246:247], v[246:247], v[28:29], v[28:29] op_sel_hi:[1,0,0]
    v_rcp_f32 v240, v240
    v_rcp_f32 v242, v242
    v_rcp_f32 v244, v244
    v_rcp_f32 v246, v246
    v_rcp_f32 v241, v241
    v_rcp_f32 v243, v243
    v_rcp_f32 v245, v245
    v_rcp_f32 v247, v247
    v_pk_mul_f32 v[240:241], v[64:65], v[240:241]
    v_pk_mul_f32 v[242:243], v[66:67], v[242:243]
    v_pk_mul_f32 v[244:245], v[68:69], v[244:245]
    v_pk_mul_f32 v[246:247], v[70:71], v[246:247]
    v_cvt_pk_bf16_f32 v160, v240, v241
    v_cvt_pk_bf16_f32 v161, v242, v243
    v_cvt_pk_bf16_f32 v162, v244, v245
    v_cvt_pk_bf16_f32 v163, v246, v247
    s_add_u32 s55, s48, s35
    buffer_store_dwordx4 v[160:163], v27, s[20:23], s55 offen sc1
    v_pk_mul_f32 v[240:241], v[72:73], s[68:69]
    v_pk_mul_f32 v[242:243], v[74:75], s[68:69]
    v_pk_mul_f32 v[244:245], v[76:77], s[68:69]
    v_pk_mul_f32 v[246:247], v[78:79], s[68:69]
    v_exp_f32 v240, v240
    v_exp_f32 v242, v242
    v_exp_f32 v244, v244
    v_exp_f32 v246, v246
    v_exp_f32 v241, v241
    v_exp_f32 v243, v243
    v_exp_f32 v245, v245
    v_exp_f32 v247, v247
    v_pk_fma_f32 v[240:241], v[240:241], v[28:29], v[28:29] op_sel_hi:[1,0,0]
    v_pk_fma_f32 v[242:243], v[242:243], v[28:29], v[28:29] op_sel_hi:[1,0,0]
    v_pk_fma_f32 v[244:245], v[244:245], v[28:29], v[28:29] op_sel_hi:[1,0,0]
    v_pk_fma_f32 v[246:247], v[246:247], v[28:29], v[28:29] op_sel_hi:[1,0,0]
    v_rcp_f32 v240, v240
    v_rcp_f32 v242, v242
    v_rcp_f32 v244, v244
    v_rcp_f32 v246, v246
    v_rcp_f32 v241, v241
    v_rcp_f32 v243, v243
    v_rcp_f32 v245, v245
    v_rcp_f32 v247, v247
    v_pk_mul_f32 v[240:241], v[72:73], v[240:241]
    v_pk_mul_f32 v[242:243], v[74:75], v[242:243]
    v_pk_mul_f32 v[244:245], v[76:77], v[244:245]
    v_pk_mul_f32 v[246:247], v[78:79], v[246:247]
    v_cvt_pk_bf16_f32 v164, v240, v241
    v_cvt_pk_bf16_f32 v165, v242, v243
    v_cvt_pk_bf16_f32 v166, v244, v245
    v_cvt_pk_bf16_f32 v167, v246, v247
    s_add_u32 s55, s48, s35
    buffer_store_dwordx4 v[164:167], v27, s[20:23], s55 offen offset:2048 sc1
    v_pk_mul_f32 v[240:241], v[80:81], s[68:69]
    v_pk_mul_f32 v[242:243], v[82:83], s[68:69]
    v_pk_mul_f32 v[244:245], v[84:85], s[68:69]
    v_pk_mul_f32 v[246:247], v[86:87], s[68:69]
    v_exp_f32 v240, v240
    v_exp_f32 v242, v242
    v_exp_f32 v244, v244
    v_exp_f32 v246, v246
    v_exp_f32 v241, v241
    v_exp_f32 v243, v243
    v_exp_f32 v245, v245
    v_exp_f32 v247, v247
    v_pk_fma_f32 v[240:241], v[240:241], v[28:29], v[28:29] op_sel:[0,1,1] op_sel_hi:[1,1,1]
    v_pk_fma_f32 v[242:243], v[242:243], v[28:29], v[28:29] op_sel:[0,1,1] op_sel_hi:[1,1,1]
    v_pk_fma_f32 v[244:245], v[244:245], v[28:29], v[28:29] op_sel:[0,1,1] op_sel_hi:[1,1,1]
    v_pk_fma_f32 v[246:247], v[246:247], v[28:29], v[28:29] op_sel:[0,1,1] op_sel_hi:[1,1,1]
    v_rcp_f32 v240, v240
    v_rcp_f32 v242, v242
    v_rcp_f32 v244, v244
    v_rcp_f32 v246, v246
    v_rcp_f32 v241, v241
    v_rcp_f32 v243, v243
    v_rcp_f32 v245, v245
    v_rcp_f32 v247, v247
    v_pk_mul_f32 v[240:241], v[80:81], v[240:241]
    v_pk_mul_f32 v[242:243], v[82:83], v[242:243]
    v_pk_mul_f32 v[244:245], v[84:85], v[244:245]
    v_pk_mul_f32 v[246:247], v[86:87], v[246:247]
    v_cvt_pk_bf16_f32 v168, v240, v241
    v_cvt_pk_bf16_f32 v169, v242, v243
    v_cvt_pk_bf16_f32 v170, v244, v245
    v_cvt_pk_bf16_f32 v171, v246, v247
    s_add_u32 s55, s49, s35
    buffer_store_dwordx4 v[168:171], v27, s[20:23], s55 offen sc1
    v_pk_mul_f32 v[240:241], v[88:89], s[68:69]
    v_pk_mul_f32 v[242:243], v[90:91], s[68:69]
    v_pk_mul_f32 v[244:245], v[92:93], s[68:69]
    v_pk_mul_f32 v[246:247], v[94:95], s[68:69]
    v_exp_f32 v240, v240
    v_exp_f32 v242, v242
    v_exp_f32 v244, v244
    v_exp_f32 v246, v246
    v_exp_f32 v241, v241
    v_exp_f32 v243, v243
    v_exp_f32 v245, v245
    v_exp_f32 v247, v247
    v_pk_fma_f32 v[240:241], v[240:241], v[28:29], v[28:29] op_sel:[0,1,1] op_sel_hi:[1,1,1]
    v_pk_fma_f32 v[242:243], v[242:243], v[28:29], v[28:29] op_sel:[0,1,1] op_sel_hi:[1,1,1]
    v_pk_fma_f32 v[244:245], v[244:245], v[28:29], v[28:29] op_sel:[0,1,1] op_sel_hi:[1,1,1]
    v_pk_fma_f32 v[246:247], v[246:247], v[28:29], v[28:29] op_sel:[0,1,1] op_sel_hi:[1,1,1]
    v_rcp_f32 v240, v240
    v_rcp_f32 v242, v242
    v_rcp_f32 v244, v244
    v_rcp_f32 v246, v246
    v_rcp_f32 v241, v241
    v_rcp_f32 v243, v243
    v_rcp_f32 v245, v245
    v_rcp_f32 v247, v247
    v_pk_mul_f32 v[240:241], v[88:89], v[240:241]
    v_pk_mul_f32 v[242:243], v[90:91], v[242:243]
    v_pk_mul_f32 v[244:245], v[92:93], v[244:245]
    v_pk_mul_f32 v[246:247], v[94:95], v[246:247]
    v_cvt_pk_bf16_f32 v172, v240, v241
    v_cvt_pk_bf16_f32 v173, v242, v243
    v_cvt_pk_bf16_f32 v174, v244, v245
    v_cvt_pk_bf16_f32 v175, v246, v247
    s_add_u32 s55, s49, s35
    buffer_store_dwordx4 v[172:175], v27, s[20:23], s55 offen offset:2048 sc1
    buffer_load_dwordx2 v[30:31], v32, s[20:23], 0 offen offset:32 sc1
    s_waitcnt vmcnt(0)
Hs_pc_1:
    s_add_u32 s54, s51, 1
    v_subrev_u32 v34, s54, v30
    v_cmp_eq_u32 s[66:67], s52, v31
    v_cmp_ge_u32 vcc, 2, v34
    s_nop 1
    s_and_b64 vcc, vcc, s[66:67]
    s_cmp_eq_u64 vcc, -1
    s_cbranch_scc1 Hs_pok_2
    s_add_u32 s63, s63, 1
    s_cmp_lt_u32 s63, 0x40000
    s_cbranch_scc0 L_end
    s_sleep 1
    buffer_load_dwordx2 v[30:31], v32, s[20:23], 0 offen offset:32 sc1
    s_waitcnt vmcnt(0)
    s_branch Hs_pc_1
Hs_pok_2:
    buffer_load_dwordx4 v[192:195], v27, s[20:23], s4 offen sc1
    buffer_load_dwordx4 v[196:199], v27, s[20:23], s4 offen offset:1024 sc1
    buffer_load_dwordx4 v[200:203], v27, s[20:23], s4 offen offset:2048 sc1
    buffer_load_dwordx4 v[204:207], v27, s[20:23], s4 offen offset:3072 sc1
    buffer_load_dwordx4 v[208:211], v27, s[20:23], s5 offen sc1
    buffer_load_dwordx4 v[212:215], v27, s[20:23], s5 offen offset:1024 sc1
    buffer_load_dwordx4 v[216:219], v27, s[20:23], s5 offen offset:2048 sc1
    buffer_load_dwordx4 v[220:223], v27, s[20:23], s5 offen offset:3072 sc1
    buffer_load_dwordx4 v[224:227], v27, s[20:23], s6 offen sc1
    buffer_load_dwordx4 v[228:231], v27, s[20:23], s6 offen offset:1024 sc1
    buffer_load_dwordx4 v[232:235], v27, s[20:23], s6 offen offset:2048 sc1
    buffer_load_dwordx4 v[236:239], v27, s[20:23], s6 offen offset:3072 sc1
    s_waitcnt vmcnt(0)
    s_branch H_join_4
L_end:
    s_endpgm
L_code_end:
.section .rodata,"a"
.p2align 6
.amdhsa_kernel gated_mix__linear_attn_block__dense_activation_silu__prompt_kernel
  .amdhsa_next_free_vgpr 512
  .amdhsa_next_free_sgpr 102
  .amdhsa_accum_offset 256
  .amdhsa_group_segment_fixed_size 0
  .amdhsa_kernarg_size 80
  .amdhsa_user_sgpr_count 2
  .amdhsa_user_sgpr_kernarg_segment_ptr 1
  .amdhsa_system_sgpr_workgroup_id_x 1
.end_amdhsa_kernel
```
